```python
import torch

def _softmax(x, axis=-1):
    return torch.softmax(x, dim=axis)
def _gelu(x):
    return torch.nn.functional.gelu(x, approximate="tanh")
def _silu(x):
    return torch.nn.functional.silu(x)
def _sigmoid(x):
    return torch.sigmoid(x)
def _layernorm(x, axis=-1, eps=1e-5):
    m = x.mean(dim=axis, keepdim=True)
    v = x.var(dim=axis, keepdim=True, unbiased=False)
    return (x - m) / torch.sqrt(v + eps)
def _scatter_add(tgt, idx, src, axis=0):
    return tgt.clone().index_add_(axis, idx, src)
def _segment_sum(src, seg, n):
    out = torch.zeros((n,) + src.shape[1:], dtype=src.dtype)
    return out.index_add_(0, seg, src)
def _pad(x, pw):
    flat = tuple(v for pair in reversed(pw) for v in pair)
    return torch.nn.functional.pad(x, flat)

kernel_name = 'sequential_preLN__spectral_gfnet__mixer_token_mlp__prompt'

def setup_inputs():

    _w = (lambda a: (lambda t: t.to(torch.bfloat16) if t.is_floating_point() else t)(torch.as_tensor(a)))
    def _A_setup():
        B, S, D = 1, 2048, 1024
        Df = D // 2 + 1
        return {
            "x": _w((lambda *s: torch.randn(*s, dtype=torch.bfloat16) * 0.05)(B, S, D)),
            "w_r": _w((lambda *s: torch.randn(*s, dtype=torch.bfloat16) * 0.4)(S, Df) * 0.02),
            "w_i": _w((lambda *s: torch.randn(*s, dtype=torch.bfloat16) * 0.4)(S, Df) * 0.02),
        }
    _A_in = _A_setup()

    def _B_setup():
        B, S, D, F = 1, 2048, 1024, 3584
        return {
            "x": _w((lambda *s: torch.randn(*s, dtype=torch.bfloat16) * 0.05)(B, S, D)),
            "w1": _w((lambda *s: torch.randn(*s, dtype=torch.bfloat16) * 0.4)(S, F) * (S ** -0.5)),
            "b1": _w((lambda *s: torch.randn(*s, dtype=torch.bfloat16) * 3.2)(F) * 0.02),
            "w2": _w((lambda *s: torch.randn(*s, dtype=torch.bfloat16) * 0.8)(F, S) * (F ** -0.5)),
            "b2": _w((lambda *s: torch.randn(*s, dtype=torch.bfloat16) * 3.2)(S) * 0.02),
        }
    _B_in = _B_setup()

    return {
        "A_x": _A_in["x"],
        "A_w_r": _A_in["w_r"],
        "A_w_i": _A_in["w_i"],
        "B_x": _B_in["x"],
        "B_w1": _B_in["w1"],
        "B_b1": _B_in["b1"],
        "B_w2": _B_in["w2"],
        "B_b2": _B_in["b2"],
    }

def reference(A_x, A_w_r, A_w_i, B_x, B_w1, B_b1, B_w2, B_b2):
    def _A_ref(x, w_r, w_i):
        B, S, D = x.shape
        X = (lambda x, axes=(-2,-1): torch.fft.rfft2(x.float(), dim=axes))(x, axes=(-2, -1))
        W = w_r + 1j * w_i
        X = X * W
        y = (lambda x, s, axes=(-2,-1): torch.fft.irfft2(x, s=s, dim=axes).to(torch.bfloat16))(X, (S, D), axes=(-2, -1))
        return y

    def _B_ref(x, w1, b1, w2, b2):
        B, S, D = x.shape
        h = _layernorm(x, axis=-1)
        u = torch.einsum("bsd,sf->bdf", h, w1) + b1
        u = _gelu(u)
        y = torch.einsum("bdf,fs->bds", u, w2) + b2
        return (lambda x, *d: x.permute(*d))(y, 0, 2, 1)

    x = A_x
    h = x + _A_ref(_layernorm(x, axis=-1), A_w_r, A_w_i)
    h2 = h + _B_ref(_layernorm(h, axis=-1), B_w1, B_b1, B_w2, B_b2)
    return h2
```

```asm
; @launch kernel=p1_kernel grid=(256,1,1) block=(256,1,1) lds=49280
; @launch kernel=mega_kernel grid=(256,1,1) block=(512,1,1) lds=131072
.amdgcn_target "amdgcn-amd-amdhsa--gfx950"
.text
.globl p1_kernel
.p2align 8
.type p1_kernel,@function
p1_kernel:
    s_cmp_ge_u32 s2, 256
    s_cbranch_scc1 L_p1_end
    s_load_dwordx4 s[4:7], s[0:1], 0
    s_load_dwordx2 s[24:25], s[0:1], 16
    s_load_dwordx2 s[60:61], s[0:1], 32
    s_load_dwordx2 s[26:27], s[0:1], 80
    s_getpc_b64 s[52:53]
L_p1_pc:
    s_sub_u32 s52, s52, L_p1_pc-p1_kernel
    s_subb_u32 s53, s53, 0
    s_lshr_b32 s54, s2, 3
    s_mul_i32 s54, s54, (L_text_end-p1_kernel+4095)/4096
    v_add_u32 v213, s54, v0
    v_lshlrev_b32 v213, 7, v213
    v_mov_b32 v211, s53
    v_add_co_u32 v210, vcc, s52, v213
    s_nop 1
    v_addc_co_u32 v211, vcc, 0, v211, vcc
    v_cmp_gt_u32 vcc, (L_text_end-p1_kernel+4095)/4096, v0
    s_nop 0
    s_and_saveexec_b64 s[54:55], vcc
    s_cbranch_execz L_p1_cp0
    v_cmp_gt_u32 vcc, L_text_end-p1_kernel, v213
    s_nop 0
    s_and_b64 exec, exec, vcc
    s_cbranch_execz L_p1_cp0
    global_load_dword v212, v[210:211], off
L_p1_cp0:
    s_mov_b64 exec, -1
    v_and_b32 v1, 63, v0
    v_lshrrev_b32 v2, 6, v0
    s_nop 0
    v_readfirstlane_b32 s28, v2
    s_lshr_b32 s29, s2, 5
    s_lshl_b32 s29, s29, 2
    s_and_b32 s30, s2, 31
    s_add_u32 s31, s29, s28
    s_lshl_b32 s31, s31, 5
    s_add_u32 s31, s31, s30
    s_lshl_b32 s31, s31, 11
    s_add_u32 s32, s31, 0x200000
    s_waitcnt lgkmcnt(0)
    s_mov_b32 s8, s4
    s_mov_b32 s9, s5
    s_mov_b32 s10, 0x400000
    s_mov_b32 s11, 0x20000
    s_mov_b32 s12, s6
    s_mov_b32 s13, s7
    s_mov_b32 s14, 0x201000
    s_mov_b32 s15, 0x20000
    s_mov_b32 s16, s24
    s_mov_b32 s17, s25
    s_mov_b32 s18, 0x201000
    s_mov_b32 s19, 0x20000
    s_mov_b32 s20, s26
    s_mov_b32 s21, s27
    s_mov_b32 s22, 0x404000
    s_mov_b32 s23, 0x20000
    s_add_u32 s56, s26, 0x2820000
    s_addc_u32 s57, s27, 0
    s_mov_b32 s58, 0x9000
    s_mov_b32 s59, 0x20000
    s_lshl_b32 s33, s2, 7
    v_mov_b32 v2, 0
    v_lshlrev_b32 v3, 15, v0
    s_cmp_lt_u32 s2, 32
    s_cselect_b32 s34, 2, 1
    v_cmp_gt_u32 vcc, s34, v0
    s_nop 0
    s_and_saveexec_b64 s[34:35], vcc
    s_cbranch_execz L_p1_nozf
    buffer_store_dword v2, v3, s[56:59], s33 offen sc0 sc1
L_p1_nozf:
    s_mov_b64 exec, -1
    s_add_u32 s56, s26, 0x2830000
    s_addc_u32 s57, s27, 0
    s_mov_b32 s58, 0x8000
    s_mov_b32 s59, 0x20000
    s_lshl_b32 s33, s2, 7
    v_mov_b32 v2, 0
    v_cmp_eq_u32 vcc, 0, v0
    s_nop 0
    s_and_saveexec_b64 s[34:35], vcc
    s_cbranch_execz L_p1_nozh
    buffer_store_dword v2, v2, s[56:59], s33 offen sc0 sc1
L_p1_nozh:
    s_mov_b64 exec, -1
    v_lshlrev_b32 v2, 4, v1
    buffer_load_dwordx4 v[4:7], v2, s[8:11], s31 offen
    buffer_load_dwordx4 v[8:11], v2, s[8:11], s31 offen offset:1024
    buffer_load_dwordx4 v[12:15], v2, s[8:11], s32 offen
    buffer_load_dwordx4 v[16:19], v2, s[8:11], s32 offen offset:1024
    v_lshlrev_b32 v220, 2, v0
    s_lshl_b32 s33, s29, 6
    s_lshl_b32 s34, s30, 1
    s_add_u32 s33, s33, s34
    s_mul_i32 s33, s33, 1026
    s_add_u32 s34, s33, 0
    buffer_load_dword v20, v220, s[12:15], s34 offen
    buffer_load_dword v28, v220, s[16:19], s34 offen
    s_add_u32 s34, s33, 65664
    buffer_load_dword v21, v220, s[12:15], s34 offen
    buffer_load_dword v29, v220, s[16:19], s34 offen
    s_add_u32 s34, s33, 131328
    buffer_load_dword v22, v220, s[12:15], s34 offen
    buffer_load_dword v30, v220, s[16:19], s34 offen
    s_add_u32 s34, s33, 196992
    buffer_load_dword v23, v220, s[12:15], s34 offen
    buffer_load_dword v31, v220, s[16:19], s34 offen
    s_add_u32 s34, s33, 1026
    buffer_load_dword v24, v220, s[12:15], s34 offen
    buffer_load_dword v32, v220, s[16:19], s34 offen
    s_add_u32 s34, s33, 66690
    buffer_load_dword v25, v220, s[12:15], s34 offen
    buffer_load_dword v33, v220, s[16:19], s34 offen
    s_add_u32 s34, s33, 132354
    buffer_load_dword v26, v220, s[12:15], s34 offen
    buffer_load_dword v34, v220, s[16:19], s34 offen
    s_add_u32 s34, s33, 198018
    buffer_load_dword v27, v220, s[12:15], s34 offen
    buffer_load_dword v35, v220, s[16:19], s34 offen
    v_and_b32 v200, 3, v1
    v_lshlrev_b32 v200, 6, v200
    v_bfe_u32 v201, v1, 2, 1
    v_add_u32 v200, v200, v201
    v_mul_u32_u24 v200, 1026, v200
    v_add_u32 v200, 1024, v200
    v_and_b32 v226, 3, v1
    v_lshlrev_b32 v226, 6, v226
    v_add_u32 v226, v226, v201
    s_lshl_b32 s49, s29, 6
    s_lshl_b32 s50, s30, 1
    s_add_u32 s49, s49, s50
    v_add_u32 v226, s49, v226
    v_sub_u32 v226, 2048, v226
    v_and_b32 v226, 2047, v226
    v_mul_u32_u24 v226, 1026, v226
    v_subrev_u32 v227, 1024, v200
    v_cmp_gt_u32 vcc, 8, v0
    s_nop 0
    s_and_saveexec_b64 s[36:37], vcc
    s_cbranch_execz L_p1_nox
    buffer_load_ushort v202, v200, s[12:15], s33 offen
    buffer_load_ushort v203, v200, s[16:19], s33 offen
    buffer_load_ushort v228, v227, s[12:15], s33 offen
    buffer_load_ushort v229, v227, s[16:19], s33 offen
    buffer_load_ushort v230, v226, s[12:15], 0 offen
    buffer_load_ushort v231, v226, s[16:19], 0 offen
    buffer_load_ushort v232, v226, s[12:15], 0 offen offset:1024
    buffer_load_ushort v233, v226, s[16:19], 0 offen offset:1024
L_p1_nox:
    s_mov_b64 exec, -1
    v_and_b32 v2, 31, v1
    v_cvt_f32_u32 v2, v2
    v_lshrrev_b32 v3, 5, v1
    v_lshlrev_b32 v3, 2, v3
    v_cvt_f32_u32 v3, v3
    v_mul_f32 v204, 0x3d000000, v2
    v_mul_f32 v205, v204, v3
    v_mul_f32 v184, 0x40a00000, v204
    v_cos_f32 v180, v204
    v_sin_f32 v181, v204
    v_cos_f32 v182, v184
    v_sin_f32 v183, v184
    v_cos_f32 v186, v205
    v_sin_f32 v187, v205
    s_nop 0
    v_pk_mul_f32 v[184:185], v[186:187], v[180:181] op_sel_hi:[1,0]
    v_pk_fma_f32 v[188:189], v[186:187], v[180:181], v[184:185] op_sel:[1,1,0] op_sel_hi:[0,1,1] neg_lo:[0,1,0]
    v_cvt_pk_bf16_f32 v36, v186, v187
    v_cvt_pk_bf16_f32 v52, -v187, v186
    v_pk_mul_f32 v[184:185], v[188:189], v[180:181] op_sel_hi:[1,0]
    v_pk_fma_f32 v[186:187], v[188:189], v[180:181], v[184:185] op_sel:[1,1,0] op_sel_hi:[0,1,1] neg_lo:[0,1,0]
    v_cvt_pk_bf16_f32 v37, v188, v189
    v_cvt_pk_bf16_f32 v53, -v189, v188
    v_pk_mul_f32 v[184:185], v[186:187], v[180:181] op_sel_hi:[1,0]
    v_pk_fma_f32 v[188:189], v[186:187], v[180:181], v[184:185] op_sel:[1,1,0] op_sel_hi:[0,1,1] neg_lo:[0,1,0]
    v_cvt_pk_bf16_f32 v38, v186, v187
    v_cvt_pk_bf16_f32 v54, -v187, v186
    v_pk_mul_f32 v[184:185], v[188:189], v[182:183] op_sel_hi:[1,0]
    v_pk_fma_f32 v[186:187], v[188:189], v[182:183], v[184:185] op_sel:[1,1,0] op_sel_hi:[0,1,1] neg_lo:[0,1,0]
    v_cvt_pk_bf16_f32 v39, v188, v189
    v_cvt_pk_bf16_f32 v55, -v189, v188
    v_pk_mul_f32 v[184:185], v[186:187], v[180:181] op_sel_hi:[1,0]
    v_pk_fma_f32 v[188:189], v[186:187], v[180:181], v[184:185] op_sel:[1,1,0] op_sel_hi:[0,1,1] neg_lo:[0,1,0]
    v_cvt_pk_bf16_f32 v40, v186, v187
    v_cvt_pk_bf16_f32 v56, -v187, v186
    v_pk_mul_f32 v[184:185], v[188:189], v[180:181] op_sel_hi:[1,0]
    v_pk_fma_f32 v[186:187], v[188:189], v[180:181], v[184:185] op_sel:[1,1,0] op_sel_hi:[0,1,1] neg_lo:[0,1,0]
    v_cvt_pk_bf16_f32 v41, v188, v189
    v_cvt_pk_bf16_f32 v57, -v189, v188
    v_pk_mul_f32 v[184:185], v[186:187], v[180:181] op_sel_hi:[1,0]
    v_pk_fma_f32 v[188:189], v[186:187], v[180:181], v[184:185] op_sel:[1,1,0] op_sel_hi:[0,1,1] neg_lo:[0,1,0]
    v_cvt_pk_bf16_f32 v42, v186, v187
    v_cvt_pk_bf16_f32 v58, -v187, v186
    v_pk_mul_f32 v[184:185], v[188:189], v[182:183] op_sel_hi:[1,0]
    v_pk_fma_f32 v[186:187], v[188:189], v[182:183], v[184:185] op_sel:[1,1,0] op_sel_hi:[0,1,1] neg_lo:[0,1,0]
    v_cvt_pk_bf16_f32 v43, v188, v189
    v_cvt_pk_bf16_f32 v59, -v189, v188
    v_pk_mul_f32 v[184:185], v[186:187], v[180:181] op_sel_hi:[1,0]
    v_pk_fma_f32 v[188:189], v[186:187], v[180:181], v[184:185] op_sel:[1,1,0] op_sel_hi:[0,1,1] neg_lo:[0,1,0]
    v_cvt_pk_bf16_f32 v44, v186, v187
    v_cvt_pk_bf16_f32 v60, -v187, v186
    v_pk_mul_f32 v[184:185], v[188:189], v[180:181] op_sel_hi:[1,0]
    v_pk_fma_f32 v[186:187], v[188:189], v[180:181], v[184:185] op_sel:[1,1,0] op_sel_hi:[0,1,1] neg_lo:[0,1,0]
    v_cvt_pk_bf16_f32 v45, v188, v189
    v_cvt_pk_bf16_f32 v61, -v189, v188
    v_pk_mul_f32 v[184:185], v[186:187], v[180:181] op_sel_hi:[1,0]
    v_pk_fma_f32 v[188:189], v[186:187], v[180:181], v[184:185] op_sel:[1,1,0] op_sel_hi:[0,1,1] neg_lo:[0,1,0]
    v_cvt_pk_bf16_f32 v46, v186, v187
    v_cvt_pk_bf16_f32 v62, -v187, v186
    v_pk_mul_f32 v[184:185], v[188:189], v[182:183] op_sel_hi:[1,0]
    v_pk_fma_f32 v[186:187], v[188:189], v[182:183], v[184:185] op_sel:[1,1,0] op_sel_hi:[0,1,1] neg_lo:[0,1,0]
    v_cvt_pk_bf16_f32 v47, v188, v189
    v_cvt_pk_bf16_f32 v63, -v189, v188
    v_pk_mul_f32 v[184:185], v[186:187], v[180:181] op_sel_hi:[1,0]
    v_pk_fma_f32 v[188:189], v[186:187], v[180:181], v[184:185] op_sel:[1,1,0] op_sel_hi:[0,1,1] neg_lo:[0,1,0]
    v_cvt_pk_bf16_f32 v48, v186, v187
    v_cvt_pk_bf16_f32 v64, -v187, v186
    v_pk_mul_f32 v[184:185], v[188:189], v[180:181] op_sel_hi:[1,0]
    v_pk_fma_f32 v[186:187], v[188:189], v[180:181], v[184:185] op_sel:[1,1,0] op_sel_hi:[0,1,1] neg_lo:[0,1,0]
    v_cvt_pk_bf16_f32 v49, v188, v189
    v_cvt_pk_bf16_f32 v65, -v189, v188
    v_pk_mul_f32 v[184:185], v[186:187], v[180:181] op_sel_hi:[1,0]
    v_pk_fma_f32 v[188:189], v[186:187], v[180:181], v[184:185] op_sel:[1,1,0] op_sel_hi:[0,1,1] neg_lo:[0,1,0]
    v_cvt_pk_bf16_f32 v50, v186, v187
    v_cvt_pk_bf16_f32 v66, -v187, v186
    v_cvt_pk_bf16_f32 v51, v188, v189
    v_cvt_pk_bf16_f32 v67, -v189, v188
    v_mul_f32 v204, 0x3a800000, v2
    v_mul_f32 v205, v204, v3
    v_mul_f32 v184, 0x40a00000, v204
    v_cos_f32 v180, v204
    v_sin_f32 v181, v204
    v_cos_f32 v182, v184
    v_sin_f32 v183, v184
    v_cos_f32 v68, v205
    v_sin_f32_e64 v69, -v205
    s_nop 0
    v_pk_mul_f32 v[184:185], v[68:69], v[180:181] op_sel_hi:[1,0]
    v_pk_fma_f32 v[70:71], v[68:69], v[180:181], v[184:185] op_sel:[1,1,0] op_sel_hi:[0,1,1] neg_hi:[0,1,0]
    v_pk_mul_f32 v[184:185], v[70:71], v[180:181] op_sel_hi:[1,0]
    v_pk_fma_f32 v[72:73], v[70:71], v[180:181], v[184:185] op_sel:[1,1,0] op_sel_hi:[0,1,1] neg_hi:[0,1,0]
    v_pk_mul_f32 v[184:185], v[72:73], v[180:181] op_sel_hi:[1,0]
    v_pk_fma_f32 v[74:75], v[72:73], v[180:181], v[184:185] op_sel:[1,1,0] op_sel_hi:[0,1,1] neg_hi:[0,1,0]
    v_pk_mul_f32 v[184:185], v[74:75], v[182:183] op_sel_hi:[1,0]
    v_pk_fma_f32 v[76:77], v[74:75], v[182:183], v[184:185] op_sel:[1,1,0] op_sel_hi:[0,1,1] neg_hi:[0,1,0]
    v_pk_mul_f32 v[184:185], v[76:77], v[180:181] op_sel_hi:[1,0]
    v_pk_fma_f32 v[78:79], v[76:77], v[180:181], v[184:185] op_sel:[1,1,0] op_sel_hi:[0,1,1] neg_hi:[0,1,0]
    v_pk_mul_f32 v[184:185], v[78:79], v[180:181] op_sel_hi:[1,0]
    v_pk_fma_f32 v[80:81], v[78:79], v[180:181], v[184:185] op_sel:[1,1,0] op_sel_hi:[0,1,1] neg_hi:[0,1,0]
    v_pk_mul_f32 v[184:185], v[80:81], v[180:181] op_sel_hi:[1,0]
    v_pk_fma_f32 v[82:83], v[80:81], v[180:181], v[184:185] op_sel:[1,1,0] op_sel_hi:[0,1,1] neg_hi:[0,1,0]
    v_pk_mul_f32 v[184:185], v[82:83], v[182:183] op_sel_hi:[1,0]
    v_pk_fma_f32 v[84:85], v[82:83], v[182:183], v[184:185] op_sel:[1,1,0] op_sel_hi:[0,1,1] neg_hi:[0,1,0]
    v_pk_mul_f32 v[184:185], v[84:85], v[180:181] op_sel_hi:[1,0]
    v_pk_fma_f32 v[86:87], v[84:85], v[180:181], v[184:185] op_sel:[1,1,0] op_sel_hi:[0,1,1] neg_hi:[0,1,0]
    v_pk_mul_f32 v[184:185], v[86:87], v[180:181] op_sel_hi:[1,0]
    v_pk_fma_f32 v[88:89], v[86:87], v[180:181], v[184:185] op_sel:[1,1,0] op_sel_hi:[0,1,1] neg_hi:[0,1,0]
    v_pk_mul_f32 v[184:185], v[88:89], v[180:181] op_sel_hi:[1,0]
    v_pk_fma_f32 v[90:91], v[88:89], v[180:181], v[184:185] op_sel:[1,1,0] op_sel_hi:[0,1,1] neg_hi:[0,1,0]
    v_pk_mul_f32 v[184:185], v[90:91], v[182:183] op_sel_hi:[1,0]
    v_pk_fma_f32 v[92:93], v[90:91], v[182:183], v[184:185] op_sel:[1,1,0] op_sel_hi:[0,1,1] neg_hi:[0,1,0]
    v_pk_mul_f32 v[184:185], v[92:93], v[180:181] op_sel_hi:[1,0]
    v_pk_fma_f32 v[94:95], v[92:93], v[180:181], v[184:185] op_sel:[1,1,0] op_sel_hi:[0,1,1] neg_hi:[0,1,0]
    v_pk_mul_f32 v[184:185], v[94:95], v[180:181] op_sel_hi:[1,0]
    v_pk_fma_f32 v[96:97], v[94:95], v[180:181], v[184:185] op_sel:[1,1,0] op_sel_hi:[0,1,1] neg_hi:[0,1,0]
    v_pk_mul_f32 v[184:185], v[96:97], v[180:181] op_sel_hi:[1,0]
    v_pk_fma_f32 v[98:99], v[96:97], v[180:181], v[184:185] op_sel:[1,1,0] op_sel_hi:[0,1,1] neg_hi:[0,1,0]
    s_lshr_b32 s44, s2, 2
    s_and_b32 s44, s44, 3
    s_mov_b32 s45, 0x05040100
    s_mov_b32 s46, 0x07060302
    s_lshl_b32 s47, s2, 6
    s_lshl_b32 s48, s28, 2
    s_add_u32 s48, s48, 16384
    v_and_b32 v2, 31, v1
    v_lshrrev_b32 v3, 5, v1
    v_and_b32 v204, 1, v2
    v_lshrrev_b32 v205, 1, v2
    v_xor_b32 v206, s44, v204
    v_lshlrev_b32 v206, 4, v206
    v_lshl_add_u32 v206, v205, 6, v206
    v_lshl_add_u32 v206, v3, 12, v206
    v_add_u32 v206, s48, v206
    v_add_u32 v205, 1, v2
    v_lshrrev_b32 v205, 1, v205
    v_add_u32 v204, 2, v204
    v_xor_b32 v207, s44, v204
    v_lshlrev_b32 v207, 4, v207
    v_lshlrev_b32 v205, 6, v205
    v_sub_u32 v207, v207, v205
    v_lshlrev_b32 v205, 12, v3
    v_sub_u32 v207, v207, v205
    v_add_u32 v207, s48, v207
    s_lshl_b32 s49, s28, 12
    s_add_u32 s49, s49, 32896
    v_bfe_u32 v204, v1, 1, 2
    v_xor_b32 v204, s44, v204
    v_lshlrev_b32 v204, 4, v204
    v_lshl_add_u32 v208, v1, 6, v204
    v_add_u32 v208, s49, v208
    v_lshrrev_b32 v204, 2, v1
    v_and_b32 v205, 3, v1
    v_bfe_u32 v218, v204, 1, 2
    v_xor_b32 v218, v218, v205
    v_lshlrev_b32 v218, 4, v218
    v_lshl_add_u32 v221, v204, 6, v218
    v_add_u32 v221, s49, v221
    s_lshl_b32 s49, s28, 6
    v_add_u32 v204, s49, v204
    v_lshlrev_b32 v204, 14, v204
    v_lshl_add_u32 v222, v205, 4, v204
    v_bfe_u32 v204, v1, 2, 1
    v_xor_b32 v204, s44, v204
    v_lshlrev_b32 v204, 4, v204
    v_and_b32 v205, 3, v1
    v_lshl_add_u32 v209, v205, 2, v204
    v_add_u32 v223, 32896, v209
    v_lshlrev_b32 v216, 4, v0
    v_add_u32 v216, 16384, v216
    v_lshrrev_b32 v204, 2, v0
    v_lshlrev_b32 v204, 14, v204
    v_and_b32 v205, 3, v0
    v_lshl_add_u32 v217, v205, 4, v204
    s_xor_b32 s49, s44, 2
    s_lshl_b32 s49, s49, 4
    s_add_u32 s49, s49, s48
    s_lshl_b32 s50, s44, 4
    s_add_u32 s50, s50, s48
    v_mov_b32 v218, s49
    v_mov_b32 v219, s50
    s_lshl_b32 s36, s28, 12
    v_lshlrev_b32 v2, 5, v1
    v_add_u32 v2, s36, v2
    v_and_b32 v3, 31, v1
    v_lshlrev_b32 v3, 2, v3
    v_lshrrev_b32 v204, 5, v1
    v_lshlrev_b32 v204, 9, v204
    v_add3_u32 v3, v3, v204, s36
    s_mov_b32 s35, 0xffff0000
    s_waitcnt vmcnt(16)
    s_add_u32 s56, s26, 0x900000
    s_addc_u32 s57, s27, 0
    s_mov_b32 s58, 0x400000
    s_mov_b32 s59, 0x20000
    v_mov_b32 v180, -1
    v_mov_b32 v181, -1
    v_mov_b32 v182, -1
    v_mov_b32 v183, -1
    v_lshlrev_b32 v234, 4, v0
    s_lshl_b32 s51, s2, 14
    buffer_store_dwordx4 v[180:183], v234, s[56:59], s51 offen sc0 sc1
    s_add_u32 s51, s51, 4096
    buffer_store_dwordx4 v[180:183], v234, s[56:59], s51 offen sc0 sc1
    s_add_u32 s51, s51, 4096
    buffer_store_dwordx4 v[180:183], v234, s[56:59], s51 offen sc0 sc1
    s_add_u32 s51, s51, 4096
    buffer_store_dwordx4 v[180:183], v234, s[56:59], s51 offen sc0 sc1
    v_lshlrev_b32 v100, 16, v4
    v_lshlrev_b32 v101, 16, v12
    v_and_b32 v102, s35, v4
    v_and_b32 v103, s35, v12
    v_lshlrev_b32 v104, 16, v5
    v_lshlrev_b32 v105, 16, v13
    v_and_b32 v106, s35, v5
    v_and_b32 v107, s35, v13
    v_lshlrev_b32 v108, 16, v6
    v_lshlrev_b32 v109, 16, v14
    v_and_b32 v110, s35, v6
    v_and_b32 v111, s35, v14
    v_lshlrev_b32 v112, 16, v7
    v_lshlrev_b32 v113, 16, v15
    v_and_b32 v114, s35, v7
    v_and_b32 v115, s35, v15
    v_lshlrev_b32 v116, 16, v8
    v_lshlrev_b32 v117, 16, v16
    v_and_b32 v118, s35, v8
    v_and_b32 v119, s35, v16
    v_lshlrev_b32 v120, 16, v9
    v_lshlrev_b32 v121, 16, v17
    v_and_b32 v122, s35, v9
    v_and_b32 v123, s35, v17
    v_lshlrev_b32 v124, 16, v10
    v_lshlrev_b32 v125, 16, v18
    v_and_b32 v126, s35, v10
    v_and_b32 v127, s35, v18
    v_lshlrev_b32 v128, 16, v11
    v_lshlrev_b32 v129, 16, v19
    v_and_b32 v130, s35, v11
    v_and_b32 v131, s35, v19
    v_pk_add_f32 v[180:181], v[100:101], v[108:109]
    v_pk_add_f32 v[182:183], v[102:103], v[110:111]
    v_pk_add_f32 v[184:185], v[104:105], v[112:113]
    v_pk_add_f32 v[186:187], v[106:107], v[114:115]
    v_pk_add_f32 v[180:181], v[180:181], v[116:117]
    v_pk_add_f32 v[182:183], v[182:183], v[118:119]
    v_pk_add_f32 v[184:185], v[184:185], v[120:121]
    v_pk_add_f32 v[186:187], v[186:187], v[122:123]
    v_pk_add_f32 v[180:181], v[180:181], v[124:125]
    v_pk_add_f32 v[182:183], v[182:183], v[126:127]
    v_pk_add_f32 v[184:185], v[184:185], v[128:129]
    v_pk_add_f32 v[186:187], v[186:187], v[130:131]
    v_pk_add_f32 v[180:181], v[180:181], v[182:183]
    v_pk_add_f32 v[184:185], v[184:185], v[186:187]
    v_pk_add_f32 v[180:181], v[180:181], v[184:185]
    s_nop 1
    v_add_f32_dpp v180, v180, v180 quad_perm:[1,0,3,2] row_mask:0xf bank_mask:0xf
    v_add_f32_dpp v181, v181, v181 quad_perm:[1,0,3,2] row_mask:0xf bank_mask:0xf
    s_nop 0
    v_add_f32_dpp v180, v180, v180 quad_perm:[2,3,0,1] row_mask:0xf bank_mask:0xf
    v_add_f32_dpp v181, v181, v181 quad_perm:[2,3,0,1] row_mask:0xf bank_mask:0xf
    s_nop 0
    v_add_f32_dpp v180, v180, v180 row_half_mirror row_mask:0xf bank_mask:0xf
    v_add_f32_dpp v181, v181, v181 row_half_mirror row_mask:0xf bank_mask:0xf
    s_nop 0
    v_add_f32_dpp v180, v180, v180 row_mirror row_mask:0xf bank_mask:0xf
    v_add_f32_dpp v181, v181, v181 row_mirror row_mask:0xf bank_mask:0xf
    s_nop 0
    v_add_f32_dpp v180, v180, v180 row_bcast:15 row_mask:0xa bank_mask:0xf
    v_add_f32_dpp v181, v181, v181 row_bcast:15 row_mask:0xa bank_mask:0xf
    s_nop 0
    v_add_f32_dpp v180, v180, v180 row_bcast:31 row_mask:0xc bank_mask:0xf
    v_add_f32_dpp v181, v181, v181 row_bcast:31 row_mask:0xc bank_mask:0xf
    v_mul_f32 v180, 0x3a800000, v180
    v_mul_f32 v181, 0x3a800000, v181
    v_mov_b32 v192, v180
    v_mov_b32 v193, v181
    v_readlane_b32 s42, v180, 63
    v_readlane_b32 s43, v181, 63
    s_nop 1
    v_pk_add_f32 v[184:185], v[100:101], s[42:43] neg_lo:[0,1] neg_hi:[0,1]
    v_pk_mul_f32 v[180:181], v[184:185], v[184:185]
    v_pk_add_f32 v[186:187], v[102:103], s[42:43] neg_lo:[0,1] neg_hi:[0,1]
    v_pk_mul_f32 v[182:183], v[186:187], v[186:187]
    v_pk_add_f32 v[188:189], v[104:105], s[42:43] neg_lo:[0,1] neg_hi:[0,1]
    v_pk_fma_f32 v[180:181], v[188:189], v[188:189], v[180:181]
    v_pk_add_f32 v[190:191], v[106:107], s[42:43] neg_lo:[0,1] neg_hi:[0,1]
    v_pk_fma_f32 v[182:183], v[190:191], v[190:191], v[182:183]
    v_pk_add_f32 v[184:185], v[108:109], s[42:43] neg_lo:[0,1] neg_hi:[0,1]
    v_pk_fma_f32 v[180:181], v[184:185], v[184:185], v[180:181]
    v_pk_add_f32 v[186:187], v[110:111], s[42:43] neg_lo:[0,1] neg_hi:[0,1]
    v_pk_fma_f32 v[182:183], v[186:187], v[186:187], v[182:183]
    v_pk_add_f32 v[188:189], v[112:113], s[42:43] neg_lo:[0,1] neg_hi:[0,1]
    v_pk_fma_f32 v[180:181], v[188:189], v[188:189], v[180:181]
    v_pk_add_f32 v[190:191], v[114:115], s[42:43] neg_lo:[0,1] neg_hi:[0,1]
    v_pk_fma_f32 v[182:183], v[190:191], v[190:191], v[182:183]
    v_pk_add_f32 v[184:185], v[116:117], s[42:43] neg_lo:[0,1] neg_hi:[0,1]
    v_pk_fma_f32 v[180:181], v[184:185], v[184:185], v[180:181]
    v_pk_add_f32 v[186:187], v[118:119], s[42:43] neg_lo:[0,1] neg_hi:[0,1]
    v_pk_fma_f32 v[182:183], v[186:187], v[186:187], v[182:183]
    v_pk_add_f32 v[188:189], v[120:121], s[42:43] neg_lo:[0,1] neg_hi:[0,1]
    v_pk_fma_f32 v[180:181], v[188:189], v[188:189], v[180:181]
    v_pk_add_f32 v[190:191], v[122:123], s[42:43] neg_lo:[0,1] neg_hi:[0,1]
    v_pk_fma_f32 v[182:183], v[190:191], v[190:191], v[182:183]
    v_pk_add_f32 v[184:185], v[124:125], s[42:43] neg_lo:[0,1] neg_hi:[0,1]
    v_pk_fma_f32 v[180:181], v[184:185], v[184:185], v[180:181]
    v_pk_add_f32 v[186:187], v[126:127], s[42:43] neg_lo:[0,1] neg_hi:[0,1]
    v_pk_fma_f32 v[182:183], v[186:187], v[186:187], v[182:183]
    v_pk_add_f32 v[188:189], v[128:129], s[42:43] neg_lo:[0,1] neg_hi:[0,1]
    v_pk_fma_f32 v[180:181], v[188:189], v[188:189], v[180:181]
    v_pk_add_f32 v[190:191], v[130:131], s[42:43] neg_lo:[0,1] neg_hi:[0,1]
    v_pk_fma_f32 v[182:183], v[190:191], v[190:191], v[182:183]
    v_pk_add_f32 v[180:181], v[180:181], v[182:183]
    s_nop 1
    v_add_f32_dpp v180, v180, v180 quad_perm:[1,0,3,2] row_mask:0xf bank_mask:0xf
    v_add_f32_dpp v181, v181, v181 quad_perm:[1,0,3,2] row_mask:0xf bank_mask:0xf
    s_nop 0
    v_add_f32_dpp v180, v180, v180 quad_perm:[2,3,0,1] row_mask:0xf bank_mask:0xf
    v_add_f32_dpp v181, v181, v181 quad_perm:[2,3,0,1] row_mask:0xf bank_mask:0xf
    s_nop 0
    v_add_f32_dpp v180, v180, v180 row_half_mirror row_mask:0xf bank_mask:0xf
    v_add_f32_dpp v181, v181, v181 row_half_mirror row_mask:0xf bank_mask:0xf
    s_nop 0
    v_add_f32_dpp v180, v180, v180 row_mirror row_mask:0xf bank_mask:0xf
    v_add_f32_dpp v181, v181, v181 row_mirror row_mask:0xf bank_mask:0xf
    s_nop 0
    v_add_f32_dpp v180, v180, v180 row_bcast:15 row_mask:0xa bank_mask:0xf
    v_add_f32_dpp v181, v181, v181 row_bcast:15 row_mask:0xa bank_mask:0xf
    s_nop 0
    v_add_f32_dpp v180, v180, v180 row_bcast:31 row_mask:0xc bank_mask:0xf
    v_add_f32_dpp v181, v181, v181 row_bcast:31 row_mask:0xc bank_mask:0xf
    v_mul_f32 v180, 0x3a800000, v180
    v_mul_f32 v181, 0x3a800000, v181
    v_add_f32 v180, 0x3727c5ac, v180
    v_add_f32 v181, 0x3727c5ac, v181
    v_rsq_f32 v180, v180
    v_rsq_f32 v181, v181
    s_nop 0
    v_mul_f32 v192, v192, v180
    v_mul_f32 v193, v193, v181
    v_readlane_b32 s40, v180, 63
    v_readlane_b32 s41, v181, 63
    v_readlane_b32 s38, v192, 63
    v_readlane_b32 s39, v193, 63
    v_mov_b32 v188, s40
    v_mov_b32 v189, s41
    v_mov_b32 v190, s38
    v_mov_b32 v191, s39
    v_pk_fma_f32 v[180:181], v[100:101], v[188:189], v[190:191] neg_lo:[0,0,1] neg_hi:[0,0,1]
    v_cvt_pk_bf16_f32 v164, v180, v181
    v_pk_fma_f32 v[182:183], v[102:103], v[188:189], v[190:191] neg_lo:[0,0,1] neg_hi:[0,0,1]
    v_cvt_pk_bf16_f32 v165, v182, v183
    v_pk_fma_f32 v[184:185], v[104:105], v[188:189], v[190:191] neg_lo:[0,0,1] neg_hi:[0,0,1]
    v_cvt_pk_bf16_f32 v166, v184, v185
    v_pk_fma_f32 v[186:187], v[106:107], v[188:189], v[190:191] neg_lo:[0,0,1] neg_hi:[0,0,1]
    v_cvt_pk_bf16_f32 v167, v186, v187
    v_pk_fma_f32 v[180:181], v[108:109], v[188:189], v[190:191] neg_lo:[0,0,1] neg_hi:[0,0,1]
    v_cvt_pk_bf16_f32 v168, v180, v181
    v_pk_fma_f32 v[182:183], v[110:111], v[188:189], v[190:191] neg_lo:[0,0,1] neg_hi:[0,0,1]
    v_cvt_pk_bf16_f32 v169, v182, v183
    v_pk_fma_f32 v[184:185], v[112:113], v[188:189], v[190:191] neg_lo:[0,0,1] neg_hi:[0,0,1]
    v_cvt_pk_bf16_f32 v170, v184, v185
    v_pk_fma_f32 v[186:187], v[114:115], v[188:189], v[190:191] neg_lo:[0,0,1] neg_hi:[0,0,1]
    v_cvt_pk_bf16_f32 v171, v186, v187
    v_pk_fma_f32 v[180:181], v[116:117], v[188:189], v[190:191] neg_lo:[0,0,1] neg_hi:[0,0,1]
    v_cvt_pk_bf16_f32 v172, v180, v181
    v_pk_fma_f32 v[182:183], v[118:119], v[188:189], v[190:191] neg_lo:[0,0,1] neg_hi:[0,0,1]
    v_cvt_pk_bf16_f32 v173, v182, v183
    v_pk_fma_f32 v[184:185], v[120:121], v[188:189], v[190:191] neg_lo:[0,0,1] neg_hi:[0,0,1]
    v_cvt_pk_bf16_f32 v174, v184, v185
    v_pk_fma_f32 v[186:187], v[122:123], v[188:189], v[190:191] neg_lo:[0,0,1] neg_hi:[0,0,1]
    v_cvt_pk_bf16_f32 v175, v186, v187
    v_pk_fma_f32 v[180:181], v[124:125], v[188:189], v[190:191] neg_lo:[0,0,1] neg_hi:[0,0,1]
    v_cvt_pk_bf16_f32 v176, v180, v181
    v_pk_fma_f32 v[182:183], v[126:127], v[188:189], v[190:191] neg_lo:[0,0,1] neg_hi:[0,0,1]
    v_cvt_pk_bf16_f32 v177, v182, v183
    v_pk_fma_f32 v[184:185], v[128:129], v[188:189], v[190:191] neg_lo:[0,0,1] neg_hi:[0,0,1]
    v_cvt_pk_bf16_f32 v178, v184, v185
    v_pk_fma_f32 v[186:187], v[130:131], v[188:189], v[190:191] neg_lo:[0,0,1] neg_hi:[0,0,1]
    v_cvt_pk_bf16_f32 v179, v186, v187
    ds_write_b128 v2, v[164:167]
    ds_write_b128 v2, v[168:171] offset:16
    ds_write_b128 v2, v[172:175] offset:2048
    ds_write_b128 v2, v[176:179] offset:2064
    s_waitcnt lgkmcnt(0)
    ds_read_b32 v164, v3 offset:0
    ds_read_b32 v165, v3 offset:128
    ds_read_b32 v166, v3 offset:256
    ds_read_b32 v167, v3 offset:384
    ds_read_b32 v168, v3 offset:1024
    ds_read_b32 v169, v3 offset:1152
    ds_read_b32 v170, v3 offset:1280
    ds_read_b32 v171, v3 offset:1408
    ds_read_b32 v172, v3 offset:2048
    ds_read_b32 v173, v3 offset:2176
    ds_read_b32 v174, v3 offset:2304
    ds_read_b32 v175, v3 offset:2432
    ds_read_b32 v176, v3 offset:3072
    ds_read_b32 v177, v3 offset:3200
    ds_read_b32 v178, v3 offset:3328
    ds_read_b32 v179, v3 offset:3456
    s_waitcnt lgkmcnt(0)
    v_mfma_f32_32x32x16_bf16 v[132:147], v[164:167], v[36:39], 0
    v_mfma_f32_32x32x16_bf16 v[148:163], v[164:167], v[52:55], 0
    v_mfma_f32_32x32x16_bf16 v[132:147], v[168:171], v[40:43], v[132:147]
    v_mfma_f32_32x32x16_bf16 v[148:163], v[168:171], v[56:59], v[148:163]
    v_mfma_f32_32x32x16_bf16 v[132:147], v[172:175], v[44:47], v[132:147]
    v_mfma_f32_32x32x16_bf16 v[148:163], v[172:175], v[60:63], v[148:163]
    v_mfma_f32_32x32x16_bf16 v[132:147], v[176:179], v[48:51], v[132:147]
    v_mfma_f32_32x32x16_bf16 v[148:163], v[176:179], v[64:67], v[148:163]
    s_nop 10
    v_pk_mul_f32 v[180:181], v[68:69], v[132:133] op_sel:[0,0] op_sel_hi:[1,0]
    v_pk_fma_f32 v[180:181], v[68:69], v[148:149], v[180:181] op_sel:[1,0,0] op_sel_hi:[0,0,1] neg_lo:[1,0,0]
    v_pk_mul_f32 v[182:183], v[70:71], v[132:133] op_sel:[0,1] op_sel_hi:[1,1]
    v_pk_fma_f32 v[182:183], v[70:71], v[148:149], v[182:183] op_sel:[1,1,0] op_sel_hi:[0,1,1] neg_lo:[1,0,0]
    v_cvt_pk_bf16_f32 v164, v180, v181
    v_pk_mul_f32 v[184:185], v[72:73], v[134:135] op_sel:[0,0] op_sel_hi:[1,0]
    v_pk_fma_f32 v[184:185], v[72:73], v[150:151], v[184:185] op_sel:[1,0,0] op_sel_hi:[0,0,1] neg_lo:[1,0,0]
    v_cvt_pk_bf16_f32 v165, v182, v183
    v_pk_mul_f32 v[186:187], v[74:75], v[134:135] op_sel:[0,1] op_sel_hi:[1,1]
    v_pk_fma_f32 v[186:187], v[74:75], v[150:151], v[186:187] op_sel:[1,1,0] op_sel_hi:[0,1,1] neg_lo:[1,0,0]
    v_cvt_pk_bf16_f32 v166, v184, v185
    v_pk_mul_f32 v[180:181], v[76:77], v[136:137] op_sel:[0,0] op_sel_hi:[1,0]
    v_pk_fma_f32 v[180:181], v[76:77], v[152:153], v[180:181] op_sel:[1,0,0] op_sel_hi:[0,0,1] neg_lo:[1,0,0]
    v_cvt_pk_bf16_f32 v167, v186, v187
    v_pk_mul_f32 v[182:183], v[78:79], v[136:137] op_sel:[0,1] op_sel_hi:[1,1]
    v_pk_fma_f32 v[182:183], v[78:79], v[152:153], v[182:183] op_sel:[1,1,0] op_sel_hi:[0,1,1] neg_lo:[1,0,0]
    v_cvt_pk_bf16_f32 v168, v180, v181
    v_pk_mul_f32 v[184:185], v[80:81], v[138:139] op_sel:[0,0] op_sel_hi:[1,0]
    v_pk_fma_f32 v[184:185], v[80:81], v[154:155], v[184:185] op_sel:[1,0,0] op_sel_hi:[0,0,1] neg_lo:[1,0,0]
    v_cvt_pk_bf16_f32 v169, v182, v183
    v_pk_mul_f32 v[186:187], v[82:83], v[138:139] op_sel:[0,1] op_sel_hi:[1,1]
    v_pk_fma_f32 v[186:187], v[82:83], v[154:155], v[186:187] op_sel:[1,1,0] op_sel_hi:[0,1,1] neg_lo:[1,0,0]
    v_cvt_pk_bf16_f32 v170, v184, v185
    v_pk_mul_f32 v[180:181], v[84:85], v[140:141] op_sel:[0,0] op_sel_hi:[1,0]
    v_pk_fma_f32 v[180:181], v[84:85], v[156:157], v[180:181] op_sel:[1,0,0] op_sel_hi:[0,0,1] neg_lo:[1,0,0]
    v_cvt_pk_bf16_f32 v171, v186, v187
    v_pk_mul_f32 v[182:183], v[86:87], v[140:141] op_sel:[0,1] op_sel_hi:[1,1]
    v_pk_fma_f32 v[182:183], v[86:87], v[156:157], v[182:183] op_sel:[1,1,0] op_sel_hi:[0,1,1] neg_lo:[1,0,0]
    v_cvt_pk_bf16_f32 v172, v180, v181
    v_pk_mul_f32 v[184:185], v[88:89], v[142:143] op_sel:[0,0] op_sel_hi:[1,0]
    v_pk_fma_f32 v[184:185], v[88:89], v[158:159], v[184:185] op_sel:[1,0,0] op_sel_hi:[0,0,1] neg_lo:[1,0,0]
    v_cvt_pk_bf16_f32 v173, v182, v183
    v_pk_mul_f32 v[186:187], v[90:91], v[142:143] op_sel:[0,1] op_sel_hi:[1,1]
    v_pk_fma_f32 v[186:187], v[90:91], v[158:159], v[186:187] op_sel:[1,1,0] op_sel_hi:[0,1,1] neg_lo:[1,0,0]
    v_cvt_pk_bf16_f32 v174, v184, v185
    v_pk_mul_f32 v[180:181], v[92:93], v[144:145] op_sel:[0,0] op_sel_hi:[1,0]
    v_pk_fma_f32 v[180:181], v[92:93], v[160:161], v[180:181] op_sel:[1,0,0] op_sel_hi:[0,0,1] neg_lo:[1,0,0]
    v_cvt_pk_bf16_f32 v175, v186, v187
    v_pk_mul_f32 v[182:183], v[94:95], v[144:145] op_sel:[0,1] op_sel_hi:[1,1]
    v_pk_fma_f32 v[182:183], v[94:95], v[160:161], v[182:183] op_sel:[1,1,0] op_sel_hi:[0,1,1] neg_lo:[1,0,0]
    v_cvt_pk_bf16_f32 v176, v180, v181
    v_pk_mul_f32 v[184:185], v[96:97], v[146:147] op_sel:[0,0] op_sel_hi:[1,0]
    v_pk_fma_f32 v[184:185], v[96:97], v[162:163], v[184:185] op_sel:[1,0,0] op_sel_hi:[0,0,1] neg_lo:[1,0,0]
    v_cvt_pk_bf16_f32 v177, v182, v183
    v_pk_mul_f32 v[186:187], v[98:99], v[146:147] op_sel:[0,1] op_sel_hi:[1,1]
    v_pk_fma_f32 v[186:187], v[98:99], v[162:163], v[186:187] op_sel:[1,1,0] op_sel_hi:[0,1,1] neg_lo:[1,0,0]
    v_cvt_pk_bf16_f32 v178, v184, v185
    v_cvt_pk_bf16_f32 v179, v186, v187
    v_mfma_f32_32x32x16_bf16 v[132:147], v[36:39], v[164:167], 0
    v_mfma_f32_32x32x16_bf16 v[148:163], v[52:55], v[164:167], 0
    v_mfma_f32_32x32x16_bf16 v[132:147], v[40:43], v[168:171], v[132:147]
    v_mfma_f32_32x32x16_bf16 v[148:163], v[56:59], v[168:171], v[148:163]
    v_mfma_f32_32x32x16_bf16 v[132:147], v[44:47], v[172:175], v[132:147]
    v_mfma_f32_32x32x16_bf16 v[148:163], v[60:63], v[172:175], v[148:163]
    v_mfma_f32_32x32x16_bf16 v[132:147], v[48:51], v[176:179], v[132:147]
    v_mfma_f32_32x32x16_bf16 v[148:163], v[64:67], v[176:179], v[148:163]
    s_nop 11
    v_cvt_pk_bf16_f32 v164, v132, v148
    ds_write_b32 v206, v164 offset:0
    v_cvt_pk_bf16_f32 v165, v133, v149
    ds_write_b32 v206, v165 offset:1024
    v_cvt_pk_bf16_f32 v166, v134, v150
    ds_write_b32 v206, v166 offset:2048
    v_cvt_pk_bf16_f32 v167, v135, v151
    ds_write_b32 v206, v167 offset:3072
    v_cvt_pk_bf16_f32 v168, v136, v152
    ds_write_b32 v206, v168 offset:8192
    v_cvt_pk_bf16_f32 v169, v137, v153
    ds_write_b32 v206, v169 offset:9216
    v_cvt_pk_bf16_f32 v170, v138, v154
    ds_write_b32 v206, v170 offset:10240
    v_cvt_pk_bf16_f32 v171, v139, v155
    ds_write_b32 v206, v171 offset:11264
    v_cvt_pk_bf16_f32 v172, v156, v140
    ds_write_b32 v207, v172 offset:16384
    v_cvt_pk_bf16_f32 v173, v157, v141
    ds_write_b32 v207, v173 offset:15360
    v_cvt_pk_bf16_f32 v174, v158, v142
    ds_write_b32 v207, v174 offset:14336
    v_cvt_pk_bf16_f32 v175, v159, v143
    ds_write_b32 v207, v175 offset:13312
    v_cvt_pk_bf16_f32 v176, v160, v144
    ds_write_b32 v207, v176 offset:8192
    v_cvt_pk_bf16_f32 v177, v161, v145
    ds_write_b32 v207, v177 offset:7168
    v_cvt_pk_bf16_f32 v178, v162, v146
    ds_write_b32 v207, v178 offset:6144
    v_cvt_pk_bf16_f32 v179, v163, v147
    ds_write_b32 v207, v179 offset:5120
    v_sub_f32 v182, v132, v156
    v_add_f32 v183, v148, v140
    v_sub_f32 v184, v148, v140
    v_add_f32 v185, v132, v156
    v_cvt_pk_bf16_f32 v180, v184, v185
    v_cvt_pk_bf16_f32 v181, v182, v183
    s_mov_b64 exec, 1
    ds_write_b32 v218, v180
    ds_write_b32 v219, v181
    s_mov_b64 exec, -1
    s_waitcnt lgkmcnt(0)
    s_barrier
    ds_read_b128 v[100:103], v216 offset:0
    ds_read_b128 v[104:107], v216 offset:4096
    ds_read_b128 v[108:111], v216 offset:8192
    ds_read_b128 v[112:115], v216 offset:12288
    s_waitcnt lgkmcnt(3)
    buffer_store_dwordx4 v[100:103], v217, s[20:23], s47 offen sc1
    s_add_u32 s47, s47, 0x100000
    s_waitcnt lgkmcnt(2)
    buffer_store_dwordx4 v[104:107], v217, s[20:23], s47 offen sc1
    s_add_u32 s47, s47, 0x100000
    s_waitcnt lgkmcnt(1)
    buffer_store_dwordx4 v[108:111], v217, s[20:23], s47 offen sc1
    s_add_u32 s47, s47, 0x100000
    s_waitcnt lgkmcnt(0)
    buffer_store_dwordx4 v[112:115], v217, s[20:23], s47 offen sc1
    s_sub_u32 s47, s47, 0x300000
    s_add_u32 s56, s26, 0x480000
    s_addc_u32 s57, s27, 0
    s_mov_b32 s58, 0x404000
    s_mov_b32 s59, 0x20000
    s_waitcnt vmcnt(4)
    v_perm_b32 v100, v28, v20, s45
    v_perm_b32 v101, v29, v21, s45
    v_perm_b32 v102, v30, v22, s45
    v_perm_b32 v103, v31, v23, s45
    v_perm_b32 v104, v32, v24, s45
    v_perm_b32 v105, v33, v25, s45
    v_perm_b32 v106, v34, v26, s45
    v_perm_b32 v107, v35, v27, s45
    v_perm_b32 v108, v28, v20, s46
    v_perm_b32 v109, v29, v21, s46
    v_perm_b32 v110, v30, v22, s46
    v_perm_b32 v111, v31, v23, s46
    v_perm_b32 v112, v32, v24, s46
    v_perm_b32 v113, v33, v25, s46
    v_perm_b32 v114, v34, v26, s46
    v_perm_b32 v115, v35, v27, s46
    ds_write_b128 v208, v[100:103]
    v_xor_b32 v204, 16, v208
    ds_write_b128 v204, v[104:107]
    v_xor_b32 v204, 32, v208
    ds_write_b128 v204, v[108:111]
    v_xor_b32 v204, 48, v208
    ds_write_b128 v204, v[112:115]
    s_add_u32 s49, s47, 0x400000
    v_cmp_gt_u32 vcc, 8, v0
    s_nop 0
    s_and_saveexec_b64 s[36:37], vcc
    s_cbranch_execz L_p1_nox2
    v_lshlrev_b32 v202, 16, v202
    v_lshlrev_b32 v203, 16, v203
    v_lshlrev_b32 v228, 16, v228
    v_lshlrev_b32 v229, 16, v229
    v_lshlrev_b32 v230, 16, v230
    v_lshlrev_b32 v231, 16, v231
    v_lshlrev_b32 v232, 16, v232
    v_lshlrev_b32 v233, 16, v233
    v_add_f32 v228, v228, v230
    v_sub_f32 v229, v229, v231
    v_add_f32 v202, v202, v232
    v_sub_f32 v203, v203, v233
    v_add_f32 v230, v228, v202
    v_add_f32 v231, v229, v203
    v_sub_f32 v232, v228, v202
    v_sub_f32 v233, v229, v203
    v_mul_f32 v230, 0x3e800000, v230
    v_mul_f32 v231, 0x3e800000, v231
    v_mul_f32 v232, 0x3e800000, v232
    v_mul_f32 v233, 0x3e800000, v233
    v_cvt_pk_bf16_f32 v202, v230, v231
    v_cvt_pk_bf16_f32 v203, v232, v233
    ds_write_b32 v223, v202
    buffer_store_dword v203, v209, s[56:59], s49 offen sc1
L_p1_nox2:
    s_mov_b64 exec, -1
    s_waitcnt lgkmcnt(0)
    ds_read_b128 v[116:119], v221 offset:0
    ds_read_b128 v[120:123], v221 offset:1024
    ds_read_b128 v[124:127], v221 offset:2048
    ds_read_b128 v[128:131], v221 offset:3072
    s_mov_b32 s49, s47
    s_waitcnt lgkmcnt(3)
    buffer_store_dwordx4 v[116:119], v222, s[56:59], s49 offen sc1
    s_add_u32 s49, s49, 262144
    s_waitcnt lgkmcnt(2)
    buffer_store_dwordx4 v[120:123], v222, s[56:59], s49 offen sc1
    s_add_u32 s49, s49, 262144
    s_waitcnt lgkmcnt(1)
    buffer_store_dwordx4 v[124:127], v222, s[56:59], s49 offen sc1
    s_add_u32 s49, s49, 262144
    s_waitcnt lgkmcnt(0)
    buffer_store_dwordx4 v[128:131], v222, s[56:59], s49 offen sc1
L_p1_end:
    s_endpgm
L_p1_endc:
.globl mega_kernel
.p2align 8
.type mega_kernel,@function
mega_kernel:
    s_cmp_ge_u32 s2, 256
    s_cbranch_scc1 L_p2_end
    s_load_dwordx2 s[26:27], s[0:1], 80
    s_load_dwordx2 s[24:25], s[0:1], 32
    s_load_dwordx2 s[4:5], s[0:1], 0
    v_and_b32 v1, 63, v0
    v_lshrrev_b32 v2, 6, v0
    s_nop 0
    v_readfirstlane_b32 s28, v2
    s_nop 0
    s_cmp_lt_u32 s28, 4
    s_cbranch_scc1 L_p2_lo
    s_waitcnt lgkmcnt(0)
    s_branch L_g1_entry
L_p2_lo:
    v_lshlrev_b32 v2, 4, v1
    s_lshr_b32 s29, s28, 1
    s_and_b32 s30, s28, 1
    s_lshl_b32 s31, s2, 14
    s_lshl_b32 s32, s28, 12
    s_add_u32 s31, s31, s32
    s_waitcnt lgkmcnt(0)
    s_mov_b32 s8, s26
    s_mov_b32 s9, s27
    s_mov_b32 s10, 0x404000
    s_mov_b32 s11, 0x20000
    s_add_u32 s20, s26, 0x480000
    s_addc_u32 s21, s27, 0
    s_mov_b32 s22, 0x404000
    s_mov_b32 s23, 0x20000
    s_add_u32 s12, s26, 0x900000
    s_addc_u32 s13, s27, 0
    s_mov_b32 s14, 0x400000
    s_mov_b32 s15, 0x20000
    s_add_u32 m0, s32, 0
    s_add_u32 s33, s31, 0
    buffer_load_dwordx4 v2, s[8:11], s33 offen lds
    s_add_u32 m0, s32, 1024
    s_add_u32 s33, s31, 1024
    buffer_load_dwordx4 v2, s[8:11], s33 offen lds
    s_add_u32 m0, s32, 2048
    s_add_u32 s33, s31, 2048
    buffer_load_dwordx4 v2, s[8:11], s33 offen lds
    s_add_u32 m0, s32, 3072
    s_add_u32 s33, s31, 3072
    buffer_load_dwordx4 v2, s[8:11], s33 offen lds
    s_or_b32 s46, s2, s29
    s_cmp_eq_u32 s46, 0
    s_cbranch_scc0 L_p2_noq
    v_bfe_u32 v3, v1, 2, 2
    v_xor_b32 v3, s30, v3
    v_lshlrev_b32 v3, 4, v3
    v_lshl_add_u32 v3, v1, 6, v3
    s_lshl_b32 s47, s30, 12
    s_add_u32 m0, s47, 32768
    s_mov_b32 s33, 4194304
    buffer_load_dwordx4 v3, s[20:23], s33 offen lds
    s_add_u32 m0, s47, 33792
    s_mov_b32 s33, 4198400
    buffer_load_dwordx4 v3, s[20:23], s33 offen lds
    s_add_u32 m0, s47, 34816
    s_mov_b32 s33, 4202496
    buffer_load_dwordx4 v3, s[20:23], s33 offen lds
    s_add_u32 m0, s47, 35840
    s_mov_b32 s33, 4206592
    buffer_load_dwordx4 v3, s[20:23], s33 offen lds
L_p2_noq:
    v_and_b32 v246, 31, v1
    v_cvt_f32_u32 v246, v246
    v_lshrrev_b32 v247, 5, v1
    v_lshlrev_b32 v247, 2, v247
    v_cvt_f32_u32 v247, v247
    v_mov_b32 v248, s30
    v_cvt_f32_u32 v248, v248
    v_mul_f32 v244, 0x3d000000, v246
    v_mul_f32 v245, v244, v247
    v_mul_f32 v232, 0x40a00000, v244
    v_cos_f32 v228, v244
    v_sin_f32 v229, v244
    v_cos_f32 v230, v232
    v_sin_f32 v231, v232
    v_cos_f32 v234, v245
    v_sin_f32 v235, v245
    s_nop 0
    v_pk_mul_f32 v[232:233], v[234:235], v[228:229] op_sel_hi:[1,0]
    v_pk_fma_f32 v[236:237], v[234:235], v[228:229], v[232:233] op_sel:[1,1,0] op_sel_hi:[0,1,1] neg_lo:[0,1,0]
    v_cvt_pk_bf16_f32 v68, v234, v235
    v_cvt_pk_bf16_f32 v84, -v235, v234
    v_pk_mul_f32 v[232:233], v[236:237], v[228:229] op_sel_hi:[1,0]
    v_pk_fma_f32 v[234:235], v[236:237], v[228:229], v[232:233] op_sel:[1,1,0] op_sel_hi:[0,1,1] neg_lo:[0,1,0]
    v_cvt_pk_bf16_f32 v69, v236, v237
    v_cvt_pk_bf16_f32 v85, -v237, v236
    v_pk_mul_f32 v[232:233], v[234:235], v[228:229] op_sel_hi:[1,0]
    v_pk_fma_f32 v[236:237], v[234:235], v[228:229], v[232:233] op_sel:[1,1,0] op_sel_hi:[0,1,1] neg_lo:[0,1,0]
    v_cvt_pk_bf16_f32 v70, v234, v235
    v_cvt_pk_bf16_f32 v86, -v235, v234
    v_pk_mul_f32 v[232:233], v[236:237], v[230:231] op_sel_hi:[1,0]
    v_pk_fma_f32 v[234:235], v[236:237], v[230:231], v[232:233] op_sel:[1,1,0] op_sel_hi:[0,1,1] neg_lo:[0,1,0]
    v_cvt_pk_bf16_f32 v71, v236, v237
    v_cvt_pk_bf16_f32 v87, -v237, v236
    v_pk_mul_f32 v[232:233], v[234:235], v[228:229] op_sel_hi:[1,0]
    v_pk_fma_f32 v[236:237], v[234:235], v[228:229], v[232:233] op_sel:[1,1,0] op_sel_hi:[0,1,1] neg_lo:[0,1,0]
    v_cvt_pk_bf16_f32 v72, v234, v235
    v_cvt_pk_bf16_f32 v88, -v235, v234
    v_pk_mul_f32 v[232:233], v[236:237], v[228:229] op_sel_hi:[1,0]
    v_pk_fma_f32 v[234:235], v[236:237], v[228:229], v[232:233] op_sel:[1,1,0] op_sel_hi:[0,1,1] neg_lo:[0,1,0]
    v_cvt_pk_bf16_f32 v73, v236, v237
    v_cvt_pk_bf16_f32 v89, -v237, v236
    v_pk_mul_f32 v[232:233], v[234:235], v[228:229] op_sel_hi:[1,0]
    v_pk_fma_f32 v[236:237], v[234:235], v[228:229], v[232:233] op_sel:[1,1,0] op_sel_hi:[0,1,1] neg_lo:[0,1,0]
    v_cvt_pk_bf16_f32 v74, v234, v235
    v_cvt_pk_bf16_f32 v90, -v235, v234
    v_pk_mul_f32 v[232:233], v[236:237], v[230:231] op_sel_hi:[1,0]
    v_pk_fma_f32 v[234:235], v[236:237], v[230:231], v[232:233] op_sel:[1,1,0] op_sel_hi:[0,1,1] neg_lo:[0,1,0]
    v_cvt_pk_bf16_f32 v75, v236, v237
    v_cvt_pk_bf16_f32 v91, -v237, v236
    v_pk_mul_f32 v[232:233], v[234:235], v[228:229] op_sel_hi:[1,0]
    v_pk_fma_f32 v[236:237], v[234:235], v[228:229], v[232:233] op_sel:[1,1,0] op_sel_hi:[0,1,1] neg_lo:[0,1,0]
    v_cvt_pk_bf16_f32 v76, v234, v235
    v_cvt_pk_bf16_f32 v92, -v235, v234
    v_pk_mul_f32 v[232:233], v[236:237], v[228:229] op_sel_hi:[1,0]
    v_pk_fma_f32 v[234:235], v[236:237], v[228:229], v[232:233] op_sel:[1,1,0] op_sel_hi:[0,1,1] neg_lo:[0,1,0]
    v_cvt_pk_bf16_f32 v77, v236, v237
    v_cvt_pk_bf16_f32 v93, -v237, v236
    v_pk_mul_f32 v[232:233], v[234:235], v[228:229] op_sel_hi:[1,0]
    v_pk_fma_f32 v[236:237], v[234:235], v[228:229], v[232:233] op_sel:[1,1,0] op_sel_hi:[0,1,1] neg_lo:[0,1,0]
    v_cvt_pk_bf16_f32 v78, v234, v235
    v_cvt_pk_bf16_f32 v94, -v235, v234
    v_pk_mul_f32 v[232:233], v[236:237], v[230:231] op_sel_hi:[1,0]
    v_pk_fma_f32 v[234:235], v[236:237], v[230:231], v[232:233] op_sel:[1,1,0] op_sel_hi:[0,1,1] neg_lo:[0,1,0]
    v_cvt_pk_bf16_f32 v79, v236, v237
    v_cvt_pk_bf16_f32 v95, -v237, v236
    v_pk_mul_f32 v[232:233], v[234:235], v[228:229] op_sel_hi:[1,0]
    v_pk_fma_f32 v[236:237], v[234:235], v[228:229], v[232:233] op_sel:[1,1,0] op_sel_hi:[0,1,1] neg_lo:[0,1,0]
    v_cvt_pk_bf16_f32 v80, v234, v235
    v_cvt_pk_bf16_f32 v96, -v235, v234
    v_pk_mul_f32 v[232:233], v[236:237], v[228:229] op_sel_hi:[1,0]
    v_pk_fma_f32 v[234:235], v[236:237], v[228:229], v[232:233] op_sel:[1,1,0] op_sel_hi:[0,1,1] neg_lo:[0,1,0]
    v_cvt_pk_bf16_f32 v81, v236, v237
    v_cvt_pk_bf16_f32 v97, -v237, v236
    v_pk_mul_f32 v[232:233], v[234:235], v[228:229] op_sel_hi:[1,0]
    v_pk_fma_f32 v[236:237], v[234:235], v[228:229], v[232:233] op_sel:[1,1,0] op_sel_hi:[0,1,1] neg_lo:[0,1,0]
    v_cvt_pk_bf16_f32 v82, v234, v235
    v_cvt_pk_bf16_f32 v98, -v235, v234
    v_cvt_pk_bf16_f32 v83, v236, v237
    v_cvt_pk_bf16_f32 v99, -v237, v236
    v_fma_f32 v244, v246, 2.0, v248
    v_mul_f32 v244, 0x3c800000, v244
    v_mul_f32 v245, v244, v247
    v_mul_f32 v232, 0x40a00000, v244
    v_cos_f32 v228, v244
    v_sin_f32 v229, v244
    v_cos_f32 v230, v232
    v_sin_f32 v231, v232
    v_cos_f32 v234, v245
    v_sin_f32 v235, v245
    s_nop 0
    v_pk_mul_f32 v[232:233], v[234:235], v[228:229] op_sel_hi:[1,0]
    v_pk_fma_f32 v[236:237], v[234:235], v[228:229], v[232:233] op_sel:[1,1,0] op_sel_hi:[0,1,1] neg_lo:[0,1,0]
    v_cvt_pk_bf16_f32 v36, v234, v235
    v_cvt_pk_bf16_f32 v52, -v235, v234
    v_pk_mul_f32 v[232:233], v[236:237], v[228:229] op_sel_hi:[1,0]
    v_pk_fma_f32 v[234:235], v[236:237], v[228:229], v[232:233] op_sel:[1,1,0] op_sel_hi:[0,1,1] neg_lo:[0,1,0]
    v_cvt_pk_bf16_f32 v37, v236, v237
    v_cvt_pk_bf16_f32 v53, -v237, v236
    v_pk_mul_f32 v[232:233], v[234:235], v[228:229] op_sel_hi:[1,0]
    v_pk_fma_f32 v[236:237], v[234:235], v[228:229], v[232:233] op_sel:[1,1,0] op_sel_hi:[0,1,1] neg_lo:[0,1,0]
    v_cvt_pk_bf16_f32 v38, v234, v235
    v_cvt_pk_bf16_f32 v54, -v235, v234
    v_pk_mul_f32 v[232:233], v[236:237], v[230:231] op_sel_hi:[1,0]
    v_pk_fma_f32 v[234:235], v[236:237], v[230:231], v[232:233] op_sel:[1,1,0] op_sel_hi:[0,1,1] neg_lo:[0,1,0]
    v_cvt_pk_bf16_f32 v39, v236, v237
    v_cvt_pk_bf16_f32 v55, -v237, v236
    v_pk_mul_f32 v[232:233], v[234:235], v[228:229] op_sel_hi:[1,0]
    v_pk_fma_f32 v[236:237], v[234:235], v[228:229], v[232:233] op_sel:[1,1,0] op_sel_hi:[0,1,1] neg_lo:[0,1,0]
    v_cvt_pk_bf16_f32 v40, v234, v235
    v_cvt_pk_bf16_f32 v56, -v235, v234
    v_pk_mul_f32 v[232:233], v[236:237], v[228:229] op_sel_hi:[1,0]
    v_pk_fma_f32 v[234:235], v[236:237], v[228:229], v[232:233] op_sel:[1,1,0] op_sel_hi:[0,1,1] neg_lo:[0,1,0]
    v_cvt_pk_bf16_f32 v41, v236, v237
    v_cvt_pk_bf16_f32 v57, -v237, v236
    v_pk_mul_f32 v[232:233], v[234:235], v[228:229] op_sel_hi:[1,0]
    v_pk_fma_f32 v[236:237], v[234:235], v[228:229], v[232:233] op_sel:[1,1,0] op_sel_hi:[0,1,1] neg_lo:[0,1,0]
    v_cvt_pk_bf16_f32 v42, v234, v235
    v_cvt_pk_bf16_f32 v58, -v235, v234
    v_pk_mul_f32 v[232:233], v[236:237], v[230:231] op_sel_hi:[1,0]
    v_pk_fma_f32 v[234:235], v[236:237], v[230:231], v[232:233] op_sel:[1,1,0] op_sel_hi:[0,1,1] neg_lo:[0,1,0]
    v_cvt_pk_bf16_f32 v43, v236, v237
    v_cvt_pk_bf16_f32 v59, -v237, v236
    v_pk_mul_f32 v[232:233], v[234:235], v[228:229] op_sel_hi:[1,0]
    v_pk_fma_f32 v[236:237], v[234:235], v[228:229], v[232:233] op_sel:[1,1,0] op_sel_hi:[0,1,1] neg_lo:[0,1,0]
    v_cvt_pk_bf16_f32 v44, v234, v235
    v_cvt_pk_bf16_f32 v60, -v235, v234
    v_pk_mul_f32 v[232:233], v[236:237], v[228:229] op_sel_hi:[1,0]
    v_pk_fma_f32 v[234:235], v[236:237], v[228:229], v[232:233] op_sel:[1,1,0] op_sel_hi:[0,1,1] neg_lo:[0,1,0]
    v_cvt_pk_bf16_f32 v45, v236, v237
    v_cvt_pk_bf16_f32 v61, -v237, v236
    v_pk_mul_f32 v[232:233], v[234:235], v[228:229] op_sel_hi:[1,0]
    v_pk_fma_f32 v[236:237], v[234:235], v[228:229], v[232:233] op_sel:[1,1,0] op_sel_hi:[0,1,1] neg_lo:[0,1,0]
    v_cvt_pk_bf16_f32 v46, v234, v235
    v_cvt_pk_bf16_f32 v62, -v235, v234
    v_pk_mul_f32 v[232:233], v[236:237], v[230:231] op_sel_hi:[1,0]
    v_pk_fma_f32 v[234:235], v[236:237], v[230:231], v[232:233] op_sel:[1,1,0] op_sel_hi:[0,1,1] neg_lo:[0,1,0]
    v_cvt_pk_bf16_f32 v47, v236, v237
    v_cvt_pk_bf16_f32 v63, -v237, v236
    v_pk_mul_f32 v[232:233], v[234:235], v[228:229] op_sel_hi:[1,0]
    v_pk_fma_f32 v[236:237], v[234:235], v[228:229], v[232:233] op_sel:[1,1,0] op_sel_hi:[0,1,1] neg_lo:[0,1,0]
    v_cvt_pk_bf16_f32 v48, v234, v235
    v_cvt_pk_bf16_f32 v64, -v235, v234
    v_pk_mul_f32 v[232:233], v[236:237], v[228:229] op_sel_hi:[1,0]
    v_pk_fma_f32 v[234:235], v[236:237], v[228:229], v[232:233] op_sel:[1,1,0] op_sel_hi:[0,1,1] neg_lo:[0,1,0]
    v_cvt_pk_bf16_f32 v49, v236, v237
    v_cvt_pk_bf16_f32 v65, -v237, v236
    v_pk_mul_f32 v[232:233], v[234:235], v[228:229] op_sel_hi:[1,0]
    v_pk_fma_f32 v[236:237], v[234:235], v[228:229], v[232:233] op_sel:[1,1,0] op_sel_hi:[0,1,1] neg_lo:[0,1,0]
    v_cvt_pk_bf16_f32 v50, v234, v235
    v_cvt_pk_bf16_f32 v66, -v235, v234
    v_cvt_pk_bf16_f32 v51, v236, v237
    v_cvt_pk_bf16_f32 v67, -v237, v236
    s_lshl_b32 s33, s30, 4
    v_and_b32 v228, 31, v1
    v_xor_b32 v228, s33, v228
    v_cvt_f32_u32 v228, v228
    v_mul_f32 v244, 0x3d000000, v228
    v_mul_f32 v245, v244, v247
    v_mul_f32 v228, 0x3c800000, v228
    v_fma_f32 v245, v228, v248, v245
    v_mul_f32 v232, 0x40a00000, v244
    v_cos_f32 v228, v244
    v_sin_f32 v229, v244
    v_cos_f32 v230, v232
    v_sin_f32 v231, v232
    v_cos_f32 v234, v245
    v_sin_f32 v235, v245
    s_nop 0
    v_pk_mul_f32 v[232:233], v[234:235], v[228:229] op_sel_hi:[1,0]
    v_pk_fma_f32 v[236:237], v[234:235], v[228:229], v[232:233] op_sel:[1,1,0] op_sel_hi:[0,1,1] neg_lo:[0,1,0]
    v_cvt_pk_bf16_f32 v100, v234, v235
    v_cvt_pk_bf16_f32 v116, -v235, v234
    v_pk_mul_f32 v[232:233], v[236:237], v[228:229] op_sel_hi:[1,0]
    v_pk_fma_f32 v[234:235], v[236:237], v[228:229], v[232:233] op_sel:[1,1,0] op_sel_hi:[0,1,1] neg_lo:[0,1,0]
    v_cvt_pk_bf16_f32 v101, v236, v237
    v_cvt_pk_bf16_f32 v117, -v237, v236
    v_pk_mul_f32 v[232:233], v[234:235], v[228:229] op_sel_hi:[1,0]
    v_pk_fma_f32 v[236:237], v[234:235], v[228:229], v[232:233] op_sel:[1,1,0] op_sel_hi:[0,1,1] neg_lo:[0,1,0]
    v_cvt_pk_bf16_f32 v102, v234, v235
    v_cvt_pk_bf16_f32 v118, -v235, v234
    v_pk_mul_f32 v[232:233], v[236:237], v[230:231] op_sel_hi:[1,0]
    v_pk_fma_f32 v[234:235], v[236:237], v[230:231], v[232:233] op_sel:[1,1,0] op_sel_hi:[0,1,1] neg_lo:[0,1,0]
    v_cvt_pk_bf16_f32 v103, v236, v237
    v_cvt_pk_bf16_f32 v119, -v237, v236
    v_pk_mul_f32 v[232:233], v[234:235], v[228:229] op_sel_hi:[1,0]
    v_pk_fma_f32 v[236:237], v[234:235], v[228:229], v[232:233] op_sel:[1,1,0] op_sel_hi:[0,1,1] neg_lo:[0,1,0]
    v_cvt_pk_bf16_f32 v104, v234, v235
    v_cvt_pk_bf16_f32 v120, -v235, v234
    v_pk_mul_f32 v[232:233], v[236:237], v[228:229] op_sel_hi:[1,0]
    v_pk_fma_f32 v[234:235], v[236:237], v[228:229], v[232:233] op_sel:[1,1,0] op_sel_hi:[0,1,1] neg_lo:[0,1,0]
    v_cvt_pk_bf16_f32 v105, v236, v237
    v_cvt_pk_bf16_f32 v121, -v237, v236
    v_pk_mul_f32 v[232:233], v[234:235], v[228:229] op_sel_hi:[1,0]
    v_pk_fma_f32 v[236:237], v[234:235], v[228:229], v[232:233] op_sel:[1,1,0] op_sel_hi:[0,1,1] neg_lo:[0,1,0]
    v_cvt_pk_bf16_f32 v106, v234, v235
    v_cvt_pk_bf16_f32 v122, -v235, v234
    v_pk_mul_f32 v[232:233], v[236:237], v[230:231] op_sel_hi:[1,0]
    v_pk_fma_f32 v[234:235], v[236:237], v[230:231], v[232:233] op_sel:[1,1,0] op_sel_hi:[0,1,1] neg_lo:[0,1,0]
    v_cvt_pk_bf16_f32 v107, v236, v237
    v_cvt_pk_bf16_f32 v123, -v237, v236
    v_pk_mul_f32 v[232:233], v[234:235], v[228:229] op_sel_hi:[1,0]
    v_pk_fma_f32 v[236:237], v[234:235], v[228:229], v[232:233] op_sel:[1,1,0] op_sel_hi:[0,1,1] neg_lo:[0,1,0]
    v_cvt_pk_bf16_f32 v108, v234, v235
    v_cvt_pk_bf16_f32 v124, -v235, v234
    v_pk_mul_f32 v[232:233], v[236:237], v[228:229] op_sel_hi:[1,0]
    v_pk_fma_f32 v[234:235], v[236:237], v[228:229], v[232:233] op_sel:[1,1,0] op_sel_hi:[0,1,1] neg_lo:[0,1,0]
    v_cvt_pk_bf16_f32 v109, v236, v237
    v_cvt_pk_bf16_f32 v125, -v237, v236
    v_pk_mul_f32 v[232:233], v[234:235], v[228:229] op_sel_hi:[1,0]
    v_pk_fma_f32 v[236:237], v[234:235], v[228:229], v[232:233] op_sel:[1,1,0] op_sel_hi:[0,1,1] neg_lo:[0,1,0]
    v_cvt_pk_bf16_f32 v110, v234, v235
    v_cvt_pk_bf16_f32 v126, -v235, v234
    v_pk_mul_f32 v[232:233], v[236:237], v[230:231] op_sel_hi:[1,0]
    v_pk_fma_f32 v[234:235], v[236:237], v[230:231], v[232:233] op_sel:[1,1,0] op_sel_hi:[0,1,1] neg_lo:[0,1,0]
    v_cvt_pk_bf16_f32 v111, v236, v237
    v_cvt_pk_bf16_f32 v127, -v237, v236
    v_pk_mul_f32 v[232:233], v[234:235], v[228:229] op_sel_hi:[1,0]
    v_pk_fma_f32 v[236:237], v[234:235], v[228:229], v[232:233] op_sel:[1,1,0] op_sel_hi:[0,1,1] neg_lo:[0,1,0]
    v_cvt_pk_bf16_f32 v112, v234, v235
    v_cvt_pk_bf16_f32 v128, -v235, v234
    v_pk_mul_f32 v[232:233], v[236:237], v[228:229] op_sel_hi:[1,0]
    v_pk_fma_f32 v[234:235], v[236:237], v[228:229], v[232:233] op_sel:[1,1,0] op_sel_hi:[0,1,1] neg_lo:[0,1,0]
    v_cvt_pk_bf16_f32 v113, v236, v237
    v_cvt_pk_bf16_f32 v129, -v237, v236
    v_pk_mul_f32 v[232:233], v[234:235], v[228:229] op_sel_hi:[1,0]
    v_pk_fma_f32 v[236:237], v[234:235], v[228:229], v[232:233] op_sel:[1,1,0] op_sel_hi:[0,1,1] neg_lo:[0,1,0]
    v_cvt_pk_bf16_f32 v114, v234, v235
    v_cvt_pk_bf16_f32 v130, -v235, v234
    v_cvt_pk_bf16_f32 v115, v236, v237
    v_cvt_pk_bf16_f32 v131, -v237, v236
    v_fma_f32 v244, v246, 2.0, v248
    v_mul_f32 v244, 0x3a000000, v244
    v_mov_b32 v228, 0x3e000000
    v_mul_f32 v229, 0xbe800000, v248
    v_add_f32 v228, v228, v229
    v_fma_f32 v245, v244, v247, v228
    v_mul_f32 v232, 0x40a00000, v244
    v_cos_f32 v228, v244
    v_sin_f32 v229, v244
    v_cos_f32 v230, v232
    v_sin_f32 v231, v232
    v_cos_f32 v132, v245
    v_sin_f32_e64 v133, -v245
    s_nop 0
    v_pk_mul_f32 v[232:233], v[132:133], v[228:229] op_sel_hi:[1,0]
    v_pk_fma_f32 v[134:135], v[132:133], v[228:229], v[232:233] op_sel:[1,1,0] op_sel_hi:[0,1,1] neg_hi:[0,1,0]
    v_pk_mul_f32 v[232:233], v[134:135], v[228:229] op_sel_hi:[1,0]
    v_pk_fma_f32 v[136:137], v[134:135], v[228:229], v[232:233] op_sel:[1,1,0] op_sel_hi:[0,1,1] neg_hi:[0,1,0]
    v_pk_mul_f32 v[232:233], v[136:137], v[228:229] op_sel_hi:[1,0]
    v_pk_fma_f32 v[138:139], v[136:137], v[228:229], v[232:233] op_sel:[1,1,0] op_sel_hi:[0,1,1] neg_hi:[0,1,0]
    v_pk_mul_f32 v[232:233], v[138:139], v[230:231] op_sel_hi:[1,0]
    v_pk_fma_f32 v[140:141], v[138:139], v[230:231], v[232:233] op_sel:[1,1,0] op_sel_hi:[0,1,1] neg_hi:[0,1,0]
    v_pk_mul_f32 v[232:233], v[140:141], v[228:229] op_sel_hi:[1,0]
    v_pk_fma_f32 v[142:143], v[140:141], v[228:229], v[232:233] op_sel:[1,1,0] op_sel_hi:[0,1,1] neg_hi:[0,1,0]
    v_pk_mul_f32 v[232:233], v[142:143], v[228:229] op_sel_hi:[1,0]
    v_pk_fma_f32 v[144:145], v[142:143], v[228:229], v[232:233] op_sel:[1,1,0] op_sel_hi:[0,1,1] neg_hi:[0,1,0]
    v_pk_mul_f32 v[232:233], v[144:145], v[228:229] op_sel_hi:[1,0]
    v_pk_fma_f32 v[146:147], v[144:145], v[228:229], v[232:233] op_sel:[1,1,0] op_sel_hi:[0,1,1] neg_hi:[0,1,0]
    v_pk_mul_f32 v[232:233], v[146:147], v[230:231] op_sel_hi:[1,0]
    v_pk_fma_f32 v[148:149], v[146:147], v[230:231], v[232:233] op_sel:[1,1,0] op_sel_hi:[0,1,1] neg_hi:[0,1,0]
    v_pk_mul_f32 v[232:233], v[148:149], v[228:229] op_sel_hi:[1,0]
    v_pk_fma_f32 v[150:151], v[148:149], v[228:229], v[232:233] op_sel:[1,1,0] op_sel_hi:[0,1,1] neg_hi:[0,1,0]
    v_pk_mul_f32 v[232:233], v[150:151], v[228:229] op_sel_hi:[1,0]
    v_pk_fma_f32 v[152:153], v[150:151], v[228:229], v[232:233] op_sel:[1,1,0] op_sel_hi:[0,1,1] neg_hi:[0,1,0]
    v_pk_mul_f32 v[232:233], v[152:153], v[228:229] op_sel_hi:[1,0]
    v_pk_fma_f32 v[154:155], v[152:153], v[228:229], v[232:233] op_sel:[1,1,0] op_sel_hi:[0,1,1] neg_hi:[0,1,0]
    v_pk_mul_f32 v[232:233], v[154:155], v[230:231] op_sel_hi:[1,0]
    v_pk_fma_f32 v[156:157], v[154:155], v[230:231], v[232:233] op_sel:[1,1,0] op_sel_hi:[0,1,1] neg_hi:[0,1,0]
    v_pk_mul_f32 v[232:233], v[156:157], v[228:229] op_sel_hi:[1,0]
    v_pk_fma_f32 v[158:159], v[156:157], v[228:229], v[232:233] op_sel:[1,1,0] op_sel_hi:[0,1,1] neg_hi:[0,1,0]
    v_pk_mul_f32 v[232:233], v[158:159], v[228:229] op_sel_hi:[1,0]
    v_pk_fma_f32 v[160:161], v[158:159], v[228:229], v[232:233] op_sel:[1,1,0] op_sel_hi:[0,1,1] neg_hi:[0,1,0]
    v_pk_mul_f32 v[232:233], v[160:161], v[228:229] op_sel_hi:[1,0]
    v_pk_fma_f32 v[162:163], v[160:161], v[228:229], v[232:233] op_sel:[1,1,0] op_sel_hi:[0,1,1] neg_hi:[0,1,0]
    v_mul_f32 v244, 0x3a800000, v246
    v_mul_f32 v245, v244, v247
    v_mul_f32 v228, 0x3a000000, v246
    v_fma_f32 v245, v228, v248, v245
    v_mul_f32 v232, 0x40a00000, v244
    v_cos_f32 v228, v244
    v_sin_f32 v229, v244
    v_cos_f32 v230, v232
    v_sin_f32 v231, v232
    v_cos_f32 v164, v245
    v_sin_f32_e64 v165, -v245
    s_nop 0
    v_pk_mul_f32 v[232:233], v[164:165], v[228:229] op_sel_hi:[1,0]
    v_pk_fma_f32 v[166:167], v[164:165], v[228:229], v[232:233] op_sel:[1,1,0] op_sel_hi:[0,1,1] neg_hi:[0,1,0]
    v_pk_mul_f32 v[232:233], v[166:167], v[228:229] op_sel_hi:[1,0]
    v_pk_fma_f32 v[168:169], v[166:167], v[228:229], v[232:233] op_sel:[1,1,0] op_sel_hi:[0,1,1] neg_hi:[0,1,0]
    v_pk_mul_f32 v[232:233], v[168:169], v[228:229] op_sel_hi:[1,0]
    v_pk_fma_f32 v[170:171], v[168:169], v[228:229], v[232:233] op_sel:[1,1,0] op_sel_hi:[0,1,1] neg_hi:[0,1,0]
    v_pk_mul_f32 v[232:233], v[170:171], v[230:231] op_sel_hi:[1,0]
    v_pk_fma_f32 v[172:173], v[170:171], v[230:231], v[232:233] op_sel:[1,1,0] op_sel_hi:[0,1,1] neg_hi:[0,1,0]
    v_pk_mul_f32 v[232:233], v[172:173], v[228:229] op_sel_hi:[1,0]
    v_pk_fma_f32 v[174:175], v[172:173], v[228:229], v[232:233] op_sel:[1,1,0] op_sel_hi:[0,1,1] neg_hi:[0,1,0]
    v_pk_mul_f32 v[232:233], v[174:175], v[228:229] op_sel_hi:[1,0]
    v_pk_fma_f32 v[176:177], v[174:175], v[228:229], v[232:233] op_sel:[1,1,0] op_sel_hi:[0,1,1] neg_hi:[0,1,0]
    v_pk_mul_f32 v[232:233], v[176:177], v[228:229] op_sel_hi:[1,0]
    v_pk_fma_f32 v[178:179], v[176:177], v[228:229], v[232:233] op_sel:[1,1,0] op_sel_hi:[0,1,1] neg_hi:[0,1,0]
    v_pk_mul_f32 v[232:233], v[178:179], v[230:231] op_sel_hi:[1,0]
    v_pk_fma_f32 v[180:181], v[178:179], v[230:231], v[232:233] op_sel:[1,1,0] op_sel_hi:[0,1,1] neg_hi:[0,1,0]
    v_pk_mul_f32 v[232:233], v[180:181], v[228:229] op_sel_hi:[1,0]
    v_pk_fma_f32 v[182:183], v[180:181], v[228:229], v[232:233] op_sel:[1,1,0] op_sel_hi:[0,1,1] neg_hi:[0,1,0]
    v_pk_mul_f32 v[232:233], v[182:183], v[228:229] op_sel_hi:[1,0]
    v_pk_fma_f32 v[184:185], v[182:183], v[228:229], v[232:233] op_sel:[1,1,0] op_sel_hi:[0,1,1] neg_hi:[0,1,0]
    v_pk_mul_f32 v[232:233], v[184:185], v[228:229] op_sel_hi:[1,0]
    v_pk_fma_f32 v[186:187], v[184:185], v[228:229], v[232:233] op_sel:[1,1,0] op_sel_hi:[0,1,1] neg_hi:[0,1,0]
    v_pk_mul_f32 v[232:233], v[186:187], v[230:231] op_sel_hi:[1,0]
    v_pk_fma_f32 v[188:189], v[186:187], v[230:231], v[232:233] op_sel:[1,1,0] op_sel_hi:[0,1,1] neg_hi:[0,1,0]
    v_pk_mul_f32 v[232:233], v[188:189], v[228:229] op_sel_hi:[1,0]
    v_pk_fma_f32 v[190:191], v[188:189], v[228:229], v[232:233] op_sel:[1,1,0] op_sel_hi:[0,1,1] neg_hi:[0,1,0]
    v_pk_mul_f32 v[232:233], v[190:191], v[228:229] op_sel_hi:[1,0]
    v_pk_fma_f32 v[192:193], v[190:191], v[228:229], v[232:233] op_sel:[1,1,0] op_sel_hi:[0,1,1] neg_hi:[0,1,0]
    v_pk_mul_f32 v[232:233], v[192:193], v[228:229] op_sel_hi:[1,0]
    v_pk_fma_f32 v[194:195], v[192:193], v[228:229], v[232:233] op_sel:[1,1,0] op_sel_hi:[0,1,1] neg_hi:[0,1,0]
    v_bfe_u32 v228, v1, 2, 2
    v_lshlrev_b32 v229, 6, v1
    v_xor_b32 v249, s29, v228
    v_lshl_add_u32 v249, v249, 4, v229
    v_xor_b32 v250, 32, v249
    s_lshl_b32 s33, s29, 1
    s_add_u32 s33, s33, s30
    v_xor_b32 v251, s33, v228
    v_lshl_add_u32 v251, v251, 4, v229
    v_add_u32 v251, 16384, v251
    s_mul_i32 s34, s30, 0x80008000
    s_mov_b32 s35, 0xffff0000
    s_waitcnt vmcnt(0)
    s_add_u32 m0, s32, 16384
    s_add_u32 s33, s31, 0
    buffer_load_dwordx4 v2, s[20:23], s33 offen lds
    s_add_u32 m0, s32, 17408
    s_add_u32 s33, s31, 1024
    buffer_load_dwordx4 v2, s[20:23], s33 offen lds
    s_add_u32 m0, s32, 18432
    s_add_u32 s33, s31, 2048
    buffer_load_dwordx4 v2, s[20:23], s33 offen lds
    s_add_u32 m0, s32, 19456
    s_add_u32 s33, s31, 3072
    buffer_load_dwordx4 v2, s[20:23], s33 offen lds
    s_barrier
    ds_read_b128 v[4:7], v249 offset:0
    ds_read_b128 v[20:23], v250 offset:0
    ds_read_b128 v[8:11], v249 offset:4096
    ds_read_b128 v[24:27], v250 offset:4096
    ds_read_b128 v[12:15], v249 offset:8192
    ds_read_b128 v[28:31], v250 offset:8192
    ds_read_b128 v[16:19], v249 offset:12288
    ds_read_b128 v[32:35], v250 offset:12288
    s_waitcnt lgkmcnt(0)
    v_xor_b32 v20, s34, v20
    v_xor_b32 v21, s34, v21
    v_xor_b32 v22, s34, v22
    v_xor_b32 v23, s34, v23
    v_xor_b32 v24, s34, v24
    v_xor_b32 v25, s34, v25
    v_xor_b32 v26, s34, v26
    v_xor_b32 v27, s34, v27
    v_xor_b32 v28, s34, v28
    v_xor_b32 v29, s34, v29
    v_xor_b32 v30, s34, v30
    v_xor_b32 v31, s34, v31
    v_xor_b32 v32, s34, v32
    v_xor_b32 v33, s34, v33
    v_xor_b32 v34, s34, v34
    v_xor_b32 v35, s34, v35
    v_mfma_f32_32x32x16_bf16 v[196:211], v[4:7], v[36:39], 0
    v_mfma_f32_32x32x16_bf16 v[212:227], v[4:7], v[52:55], 0
    v_mfma_f32_32x32x16_bf16 v[196:211], v[8:11], v[40:43], v[196:211]
    v_mfma_f32_32x32x16_bf16 v[212:227], v[8:11], v[56:59], v[212:227]
    v_mfma_f32_32x32x16_bf16 v[196:211], v[12:15], v[44:47], v[196:211]
    v_mfma_f32_32x32x16_bf16 v[212:227], v[12:15], v[60:63], v[212:227]
    v_mfma_f32_32x32x16_bf16 v[196:211], v[16:19], v[48:51], v[196:211]
    v_mfma_f32_32x32x16_bf16 v[212:227], v[16:19], v[64:67], v[212:227]
    v_mfma_f32_32x32x16_bf16 v[196:211], v[20:23], v[36:39], v[196:211]
    v_mfma_f32_32x32x16_bf16 v[212:227], v[20:23], v[52:55], v[212:227]
    v_mfma_f32_32x32x16_bf16 v[196:211], v[24:27], v[40:43], v[196:211]
    v_mfma_f32_32x32x16_bf16 v[212:227], v[24:27], v[56:59], v[212:227]
    v_mfma_f32_32x32x16_bf16 v[196:211], v[28:31], v[44:47], v[196:211]
    v_mfma_f32_32x32x16_bf16 v[212:227], v[28:31], v[60:63], v[212:227]
    v_mfma_f32_32x32x16_bf16 v[196:211], v[32:35], v[48:51], v[196:211]
    v_mfma_f32_32x32x16_bf16 v[212:227], v[32:35], v[64:67], v[212:227]
    s_nop 10
    v_pk_mul_f32 v[228:229], v[132:133], v[196:197] op_sel:[0,0] op_sel_hi:[1,0]
    v_pk_fma_f32 v[228:229], v[132:133], v[212:213], v[228:229] op_sel:[1,0,0] op_sel_hi:[0,0,1] neg_lo:[1,0,0]
    v_pk_mul_f32 v[230:231], v[134:135], v[196:197] op_sel:[0,1] op_sel_hi:[1,1]
    v_pk_fma_f32 v[230:231], v[134:135], v[212:213], v[230:231] op_sel:[1,1,0] op_sel_hi:[0,1,1] neg_lo:[1,0,0]
    v_cvt_pk_bf16_f32 v4, v228, v229
    v_pk_mul_f32 v[232:233], v[136:137], v[198:199] op_sel:[0,0] op_sel_hi:[1,0]
    v_pk_fma_f32 v[232:233], v[136:137], v[214:215], v[232:233] op_sel:[1,0,0] op_sel_hi:[0,0,1] neg_lo:[1,0,0]
    v_cvt_pk_bf16_f32 v5, v230, v231
    v_pk_mul_f32 v[234:235], v[138:139], v[198:199] op_sel:[0,1] op_sel_hi:[1,1]
    v_pk_fma_f32 v[234:235], v[138:139], v[214:215], v[234:235] op_sel:[1,1,0] op_sel_hi:[0,1,1] neg_lo:[1,0,0]
    v_cvt_pk_bf16_f32 v6, v232, v233
    v_pk_mul_f32 v[228:229], v[140:141], v[200:201] op_sel:[0,0] op_sel_hi:[1,0]
    v_pk_fma_f32 v[228:229], v[140:141], v[216:217], v[228:229] op_sel:[1,0,0] op_sel_hi:[0,0,1] neg_lo:[1,0,0]
    v_cvt_pk_bf16_f32 v7, v234, v235
    v_pk_mul_f32 v[230:231], v[142:143], v[200:201] op_sel:[0,1] op_sel_hi:[1,1]
    v_pk_fma_f32 v[230:231], v[142:143], v[216:217], v[230:231] op_sel:[1,1,0] op_sel_hi:[0,1,1] neg_lo:[1,0,0]
    v_cvt_pk_bf16_f32 v8, v228, v229
    v_pk_mul_f32 v[232:233], v[144:145], v[202:203] op_sel:[0,0] op_sel_hi:[1,0]
    v_pk_fma_f32 v[232:233], v[144:145], v[218:219], v[232:233] op_sel:[1,0,0] op_sel_hi:[0,0,1] neg_lo:[1,0,0]
    v_cvt_pk_bf16_f32 v9, v230, v231
    v_pk_mul_f32 v[234:235], v[146:147], v[202:203] op_sel:[0,1] op_sel_hi:[1,1]
    v_pk_fma_f32 v[234:235], v[146:147], v[218:219], v[234:235] op_sel:[1,1,0] op_sel_hi:[0,1,1] neg_lo:[1,0,0]
    v_cvt_pk_bf16_f32 v10, v232, v233
    v_pk_mul_f32 v[228:229], v[148:149], v[204:205] op_sel:[0,0] op_sel_hi:[1,0]
    v_pk_fma_f32 v[228:229], v[148:149], v[220:221], v[228:229] op_sel:[1,0,0] op_sel_hi:[0,0,1] neg_lo:[1,0,0]
    v_cvt_pk_bf16_f32 v11, v234, v235
    v_pk_mul_f32 v[230:231], v[150:151], v[204:205] op_sel:[0,1] op_sel_hi:[1,1]
    v_pk_fma_f32 v[230:231], v[150:151], v[220:221], v[230:231] op_sel:[1,1,0] op_sel_hi:[0,1,1] neg_lo:[1,0,0]
    v_cvt_pk_bf16_f32 v12, v228, v229
    v_pk_mul_f32 v[232:233], v[152:153], v[206:207] op_sel:[0,0] op_sel_hi:[1,0]
    v_pk_fma_f32 v[232:233], v[152:153], v[222:223], v[232:233] op_sel:[1,0,0] op_sel_hi:[0,0,1] neg_lo:[1,0,0]
    v_cvt_pk_bf16_f32 v13, v230, v231
    v_pk_mul_f32 v[234:235], v[154:155], v[206:207] op_sel:[0,1] op_sel_hi:[1,1]
    v_pk_fma_f32 v[234:235], v[154:155], v[222:223], v[234:235] op_sel:[1,1,0] op_sel_hi:[0,1,1] neg_lo:[1,0,0]
    v_cvt_pk_bf16_f32 v14, v232, v233
    v_pk_mul_f32 v[228:229], v[156:157], v[208:209] op_sel:[0,0] op_sel_hi:[1,0]
    v_pk_fma_f32 v[228:229], v[156:157], v[224:225], v[228:229] op_sel:[1,0,0] op_sel_hi:[0,0,1] neg_lo:[1,0,0]
    v_cvt_pk_bf16_f32 v15, v234, v235
    v_pk_mul_f32 v[230:231], v[158:159], v[208:209] op_sel:[0,1] op_sel_hi:[1,1]
    v_pk_fma_f32 v[230:231], v[158:159], v[224:225], v[230:231] op_sel:[1,1,0] op_sel_hi:[0,1,1] neg_lo:[1,0,0]
    v_cvt_pk_bf16_f32 v16, v228, v229
    v_pk_mul_f32 v[232:233], v[160:161], v[210:211] op_sel:[0,0] op_sel_hi:[1,0]
    v_pk_fma_f32 v[232:233], v[160:161], v[226:227], v[232:233] op_sel:[1,0,0] op_sel_hi:[0,0,1] neg_lo:[1,0,0]
    v_cvt_pk_bf16_f32 v17, v230, v231
    v_pk_mul_f32 v[234:235], v[162:163], v[210:211] op_sel:[0,1] op_sel_hi:[1,1]
    v_pk_fma_f32 v[234:235], v[162:163], v[226:227], v[234:235] op_sel:[1,1,0] op_sel_hi:[0,1,1] neg_lo:[1,0,0]
    v_cvt_pk_bf16_f32 v18, v232, v233
    v_cvt_pk_bf16_f32 v19, v234, v235
    s_waitcnt vmcnt(0)
    s_barrier
    ds_read_b128 v[20:23], v251 offset:0
    ds_read_b128 v[24:27], v251 offset:4096
    ds_read_b128 v[28:31], v251 offset:8192
    ds_read_b128 v[32:35], v251 offset:12288
    v_mfma_f32_32x32x16_bf16 v[196:211], v[68:71], v[4:7], 0
    v_mfma_f32_32x32x16_bf16 v[212:227], v[84:87], v[4:7], 0
    v_mfma_f32_32x32x16_bf16 v[196:211], v[72:75], v[8:11], v[196:211]
    v_mfma_f32_32x32x16_bf16 v[212:227], v[88:91], v[8:11], v[212:227]
    v_mfma_f32_32x32x16_bf16 v[196:211], v[76:79], v[12:15], v[196:211]
    v_mfma_f32_32x32x16_bf16 v[212:227], v[92:95], v[12:15], v[212:227]
    v_mfma_f32_32x32x16_bf16 v[196:211], v[80:83], v[16:19], v[196:211]
    v_mfma_f32_32x32x16_bf16 v[212:227], v[96:99], v[16:19], v[212:227]
    s_waitcnt lgkmcnt(0)
    v_lshlrev_b32 v36, 16, v20
    v_and_b32 v37, s35, v20
    v_lshlrev_b32 v38, 16, v21
    v_and_b32 v39, s35, v21
    v_lshlrev_b32 v40, 16, v22
    v_and_b32 v41, s35, v22
    v_lshlrev_b32 v42, 16, v23
    v_and_b32 v43, s35, v23
    v_lshlrev_b32 v44, 16, v24
    v_and_b32 v45, s35, v24
    v_lshlrev_b32 v46, 16, v25
    v_and_b32 v47, s35, v25
    v_lshlrev_b32 v48, 16, v26
    v_and_b32 v49, s35, v26
    v_lshlrev_b32 v50, 16, v27
    v_and_b32 v51, s35, v27
    v_lshlrev_b32 v52, 16, v28
    v_and_b32 v53, s35, v28
    v_lshlrev_b32 v54, 16, v29
    v_and_b32 v55, s35, v29
    v_lshlrev_b32 v56, 16, v30
    v_and_b32 v57, s35, v30
    v_lshlrev_b32 v58, 16, v31
    v_and_b32 v59, s35, v31
    v_lshlrev_b32 v60, 16, v32
    v_and_b32 v61, s35, v32
    v_lshlrev_b32 v62, 16, v33
    v_and_b32 v63, s35, v33
    v_lshlrev_b32 v64, 16, v34
    v_and_b32 v65, s35, v34
    v_lshlrev_b32 v66, 16, v35
    v_and_b32 v67, s35, v35
    s_or_b32 s46, s2, s29
    s_cmp_eq_u32 s46, 0
    s_cbranch_scc1 L_p2_spec
    v_pk_mul_f32 v[228:229], v[36:37], v[196:197] op_sel:[0,0] op_sel_hi:[1,0]
    v_pk_fma_f32 v[228:229], v[36:37], v[212:213], v[228:229] op_sel:[1,0,0] op_sel_hi:[0,0,1] neg_lo:[1,0,0]
    v_pk_mul_f32 v[230:231], v[38:39], v[196:197] op_sel:[0,1] op_sel_hi:[1,1]
    v_pk_fma_f32 v[230:231], v[38:39], v[212:213], v[230:231] op_sel:[1,1,0] op_sel_hi:[0,1,1] neg_lo:[1,0,0]
    v_cvt_pk_bf16_f32 v4, v228, -v229
    v_pk_mul_f32 v[232:233], v[40:41], v[198:199] op_sel:[0,0] op_sel_hi:[1,0]
    v_pk_fma_f32 v[232:233], v[40:41], v[214:215], v[232:233] op_sel:[1,0,0] op_sel_hi:[0,0,1] neg_lo:[1,0,0]
    v_cvt_pk_bf16_f32 v5, v230, -v231
    v_pk_mul_f32 v[234:235], v[42:43], v[198:199] op_sel:[0,1] op_sel_hi:[1,1]
    v_pk_fma_f32 v[234:235], v[42:43], v[214:215], v[234:235] op_sel:[1,1,0] op_sel_hi:[0,1,1] neg_lo:[1,0,0]
    v_cvt_pk_bf16_f32 v6, v232, -v233
    v_pk_mul_f32 v[228:229], v[44:45], v[200:201] op_sel:[0,0] op_sel_hi:[1,0]
    v_pk_fma_f32 v[228:229], v[44:45], v[216:217], v[228:229] op_sel:[1,0,0] op_sel_hi:[0,0,1] neg_lo:[1,0,0]
    v_cvt_pk_bf16_f32 v7, v234, -v235
    v_pk_mul_f32 v[230:231], v[46:47], v[200:201] op_sel:[0,1] op_sel_hi:[1,1]
    v_pk_fma_f32 v[230:231], v[46:47], v[216:217], v[230:231] op_sel:[1,1,0] op_sel_hi:[0,1,1] neg_lo:[1,0,0]
    v_cvt_pk_bf16_f32 v8, v228, -v229
    v_pk_mul_f32 v[232:233], v[48:49], v[202:203] op_sel:[0,0] op_sel_hi:[1,0]
    v_pk_fma_f32 v[232:233], v[48:49], v[218:219], v[232:233] op_sel:[1,0,0] op_sel_hi:[0,0,1] neg_lo:[1,0,0]
    v_cvt_pk_bf16_f32 v9, v230, -v231
    v_pk_mul_f32 v[234:235], v[50:51], v[202:203] op_sel:[0,1] op_sel_hi:[1,1]
    v_pk_fma_f32 v[234:235], v[50:51], v[218:219], v[234:235] op_sel:[1,1,0] op_sel_hi:[0,1,1] neg_lo:[1,0,0]
    v_cvt_pk_bf16_f32 v10, v232, -v233
    v_pk_mul_f32 v[228:229], v[52:53], v[204:205] op_sel:[0,0] op_sel_hi:[1,0]
    v_pk_fma_f32 v[228:229], v[52:53], v[220:221], v[228:229] op_sel:[1,0,0] op_sel_hi:[0,0,1] neg_lo:[1,0,0]
    v_cvt_pk_bf16_f32 v11, v234, -v235
    v_pk_mul_f32 v[230:231], v[54:55], v[204:205] op_sel:[0,1] op_sel_hi:[1,1]
    v_pk_fma_f32 v[230:231], v[54:55], v[220:221], v[230:231] op_sel:[1,1,0] op_sel_hi:[0,1,1] neg_lo:[1,0,0]
    v_cvt_pk_bf16_f32 v12, v228, -v229
    v_pk_mul_f32 v[232:233], v[56:57], v[206:207] op_sel:[0,0] op_sel_hi:[1,0]
    v_pk_fma_f32 v[232:233], v[56:57], v[222:223], v[232:233] op_sel:[1,0,0] op_sel_hi:[0,0,1] neg_lo:[1,0,0]
    v_cvt_pk_bf16_f32 v13, v230, -v231
    v_pk_mul_f32 v[234:235], v[58:59], v[206:207] op_sel:[0,1] op_sel_hi:[1,1]
    v_pk_fma_f32 v[234:235], v[58:59], v[222:223], v[234:235] op_sel:[1,1,0] op_sel_hi:[0,1,1] neg_lo:[1,0,0]
    v_cvt_pk_bf16_f32 v14, v232, -v233
    v_pk_mul_f32 v[228:229], v[60:61], v[208:209] op_sel:[0,0] op_sel_hi:[1,0]
    v_pk_fma_f32 v[228:229], v[60:61], v[224:225], v[228:229] op_sel:[1,0,0] op_sel_hi:[0,0,1] neg_lo:[1,0,0]
    v_cvt_pk_bf16_f32 v15, v234, -v235
    v_pk_mul_f32 v[230:231], v[62:63], v[208:209] op_sel:[0,1] op_sel_hi:[1,1]
    v_pk_fma_f32 v[230:231], v[62:63], v[224:225], v[230:231] op_sel:[1,1,0] op_sel_hi:[0,1,1] neg_lo:[1,0,0]
    v_cvt_pk_bf16_f32 v16, v228, -v229
    v_pk_mul_f32 v[232:233], v[64:65], v[210:211] op_sel:[0,0] op_sel_hi:[1,0]
    v_pk_fma_f32 v[232:233], v[64:65], v[226:227], v[232:233] op_sel:[1,0,0] op_sel_hi:[0,0,1] neg_lo:[1,0,0]
    v_cvt_pk_bf16_f32 v17, v230, -v231
    v_pk_mul_f32 v[234:235], v[66:67], v[210:211] op_sel:[0,1] op_sel_hi:[1,1]
    v_pk_fma_f32 v[234:235], v[66:67], v[226:227], v[234:235] op_sel:[1,1,0] op_sel_hi:[0,1,1] neg_lo:[1,0,0]
    v_cvt_pk_bf16_f32 v18, v232, -v233
    v_cvt_pk_bf16_f32 v19, v234, -v235
L_p2_specd:
    v_mfma_f32_32x32x16_bf16 v[196:211], v[4:7], v[68:71], 0
    v_mfma_f32_32x32x16_bf16 v[212:227], v[4:7], v[84:87], 0
    v_mfma_f32_32x32x16_bf16 v[196:211], v[8:11], v[72:75], v[196:211]
    v_mfma_f32_32x32x16_bf16 v[212:227], v[8:11], v[88:91], v[212:227]
    v_mfma_f32_32x32x16_bf16 v[196:211], v[12:15], v[76:79], v[196:211]
    v_mfma_f32_32x32x16_bf16 v[212:227], v[12:15], v[92:95], v[212:227]
    v_mfma_f32_32x32x16_bf16 v[196:211], v[16:19], v[80:83], v[196:211]
    v_mfma_f32_32x32x16_bf16 v[212:227], v[16:19], v[96:99], v[212:227]
    s_nop 10
    v_pk_mul_f32 v[228:229], v[164:165], v[196:197] op_sel:[0,0] op_sel_hi:[1,0]
    v_pk_fma_f32 v[228:229], v[164:165], v[212:213], v[228:229] op_sel:[1,0,0] op_sel_hi:[0,0,1] neg_lo:[1,0,0]
    v_pk_mul_f32 v[230:231], v[166:167], v[196:197] op_sel:[0,1] op_sel_hi:[1,1]
    v_pk_fma_f32 v[230:231], v[166:167], v[212:213], v[230:231] op_sel:[1,1,0] op_sel_hi:[0,1,1] neg_lo:[1,0,0]
    v_cvt_pk_bf16_f32 v4, v228, v229
    v_pk_mul_f32 v[232:233], v[168:169], v[198:199] op_sel:[0,0] op_sel_hi:[1,0]
    v_pk_fma_f32 v[232:233], v[168:169], v[214:215], v[232:233] op_sel:[1,0,0] op_sel_hi:[0,0,1] neg_lo:[1,0,0]
    v_cvt_pk_bf16_f32 v5, v230, v231
    v_pk_mul_f32 v[234:235], v[170:171], v[198:199] op_sel:[0,1] op_sel_hi:[1,1]
    v_pk_fma_f32 v[234:235], v[170:171], v[214:215], v[234:235] op_sel:[1,1,0] op_sel_hi:[0,1,1] neg_lo:[1,0,0]
    v_cvt_pk_bf16_f32 v6, v232, v233
    v_pk_mul_f32 v[228:229], v[172:173], v[200:201] op_sel:[0,0] op_sel_hi:[1,0]
    v_pk_fma_f32 v[228:229], v[172:173], v[216:217], v[228:229] op_sel:[1,0,0] op_sel_hi:[0,0,1] neg_lo:[1,0,0]
    v_cvt_pk_bf16_f32 v7, v234, v235
    v_pk_mul_f32 v[230:231], v[174:175], v[200:201] op_sel:[0,1] op_sel_hi:[1,1]
    v_pk_fma_f32 v[230:231], v[174:175], v[216:217], v[230:231] op_sel:[1,1,0] op_sel_hi:[0,1,1] neg_lo:[1,0,0]
    v_cvt_pk_bf16_f32 v8, v228, v229
    v_pk_mul_f32 v[232:233], v[176:177], v[202:203] op_sel:[0,0] op_sel_hi:[1,0]
    v_pk_fma_f32 v[232:233], v[176:177], v[218:219], v[232:233] op_sel:[1,0,0] op_sel_hi:[0,0,1] neg_lo:[1,0,0]
    v_cvt_pk_bf16_f32 v9, v230, v231
    v_pk_mul_f32 v[234:235], v[178:179], v[202:203] op_sel:[0,1] op_sel_hi:[1,1]
    v_pk_fma_f32 v[234:235], v[178:179], v[218:219], v[234:235] op_sel:[1,1,0] op_sel_hi:[0,1,1] neg_lo:[1,0,0]
    v_cvt_pk_bf16_f32 v10, v232, v233
    v_pk_mul_f32 v[228:229], v[180:181], v[204:205] op_sel:[0,0] op_sel_hi:[1,0]
    v_pk_fma_f32 v[228:229], v[180:181], v[220:221], v[228:229] op_sel:[1,0,0] op_sel_hi:[0,0,1] neg_lo:[1,0,0]
    v_cvt_pk_bf16_f32 v11, v234, v235
    v_pk_mul_f32 v[230:231], v[182:183], v[204:205] op_sel:[0,1] op_sel_hi:[1,1]
    v_pk_fma_f32 v[230:231], v[182:183], v[220:221], v[230:231] op_sel:[1,1,0] op_sel_hi:[0,1,1] neg_lo:[1,0,0]
    v_cvt_pk_bf16_f32 v12, v228, v229
    v_pk_mul_f32 v[232:233], v[184:185], v[206:207] op_sel:[0,0] op_sel_hi:[1,0]
    v_pk_fma_f32 v[232:233], v[184:185], v[222:223], v[232:233] op_sel:[1,0,0] op_sel_hi:[0,0,1] neg_lo:[1,0,0]
    v_cvt_pk_bf16_f32 v13, v230, v231
    v_pk_mul_f32 v[234:235], v[186:187], v[206:207] op_sel:[0,1] op_sel_hi:[1,1]
    v_pk_fma_f32 v[234:235], v[186:187], v[222:223], v[234:235] op_sel:[1,1,0] op_sel_hi:[0,1,1] neg_lo:[1,0,0]
    v_cvt_pk_bf16_f32 v14, v232, v233
    v_pk_mul_f32 v[228:229], v[188:189], v[208:209] op_sel:[0,0] op_sel_hi:[1,0]
    v_pk_fma_f32 v[228:229], v[188:189], v[224:225], v[228:229] op_sel:[1,0,0] op_sel_hi:[0,0,1] neg_lo:[1,0,0]
    v_cvt_pk_bf16_f32 v15, v234, v235
    v_pk_mul_f32 v[230:231], v[190:191], v[208:209] op_sel:[0,1] op_sel_hi:[1,1]
    v_pk_fma_f32 v[230:231], v[190:191], v[224:225], v[230:231] op_sel:[1,1,0] op_sel_hi:[0,1,1] neg_lo:[1,0,0]
    v_cvt_pk_bf16_f32 v16, v228, v229
    v_pk_mul_f32 v[232:233], v[192:193], v[210:211] op_sel:[0,0] op_sel_hi:[1,0]
    v_pk_fma_f32 v[232:233], v[192:193], v[226:227], v[232:233] op_sel:[1,0,0] op_sel_hi:[0,0,1] neg_lo:[1,0,0]
    v_cvt_pk_bf16_f32 v17, v230, v231
    v_pk_mul_f32 v[234:235], v[194:195], v[210:211] op_sel:[0,1] op_sel_hi:[1,1]
    v_pk_fma_f32 v[234:235], v[194:195], v[226:227], v[234:235] op_sel:[1,1,0] op_sel_hi:[0,1,1] neg_lo:[1,0,0]
    v_cvt_pk_bf16_f32 v18, v232, v233
    v_cvt_pk_bf16_f32 v19, v234, v235
    v_mfma_f32_32x32x16_bf16 v[196:211], v[100:103], v[4:7], 0
    v_mfma_f32_32x32x16_bf16 v[212:227], v[116:119], v[4:7], 0
    v_mfma_f32_32x32x16_bf16 v[196:211], v[104:107], v[8:11], v[196:211]
    v_mfma_f32_32x32x16_bf16 v[212:227], v[120:123], v[8:11], v[212:227]
    v_mfma_f32_32x32x16_bf16 v[196:211], v[108:111], v[12:15], v[196:211]
    v_mfma_f32_32x32x16_bf16 v[212:227], v[124:127], v[12:15], v[212:227]
    v_mfma_f32_32x32x16_bf16 v[196:211], v[112:115], v[16:19], v[196:211]
    v_mfma_f32_32x32x16_bf16 v[212:227], v[128:131], v[16:19], v[212:227]
    s_lshl_b32 s36, s28, 12
    s_add_u32 s36, s36, 32768
    v_lshl_add_u32 v252, v1, 4, s36
    s_nop 7
    ds_write_b128 v252, v[204:207]
    ds_write_b128 v252, v[208:211] offset:1024
    ds_write_b128 v252, v[220:223] offset:2048
    ds_write_b128 v252, v[224:227] offset:3072
    v_xor_b32 v252, 4096, v252
    s_cmp_eq_u32 s30, 0
    s_cselect_b32 s40, 0x3f800000, 0xbf800000
    s_mov_b32 s42, s40
    s_waitcnt lgkmcnt(0)
    s_barrier
    ds_read_b128 v[36:39], v252
    ds_read_b128 v[40:43], v252 offset:1024
    ds_read_b128 v[44:47], v252 offset:2048
    ds_read_b128 v[48:51], v252 offset:3072
    v_bfe_u32 v228, v1, 1, 2
    v_xor_b32 v229, s29, v228
    v_xor_b32 v230, 2, v229
    s_lshl_b32 s43, s30, 13
    s_add_u32 s43, s43, 49152
    v_lshl_add_u32 v231, v1, 6, s43
    v_lshl_add_u32 v253, v229, 4, v231
    v_lshl_add_u32 v254, v230, 4, v231
    s_waitcnt lgkmcnt(0)
    s_cmp_eq_u32 s46, 0
    s_cbranch_scc1 L_p2_spost
    v_pk_add_f32 v[132:133], v[196:197], v[36:37]
    v_pk_add_f32 v[134:135], v[212:213], v[44:45]
    v_pk_add_f32 v[136:137], v[196:197], v[36:37] neg_lo:[0,1] neg_hi:[0,1]
    v_pk_add_f32 v[138:139], v[212:213], v[44:45] neg_lo:[0,1] neg_hi:[0,1]
    v_pk_fma_f32 v[140:141], v[138:139], s[42:43], v[132:133] op_sel_hi:[1,0,1]
    v_pk_fma_f32 v[144:145], v[138:139], s[42:43], v[132:133] op_sel_hi:[1,0,1] neg_lo:[1,0,0] neg_hi:[1,0,0]
    v_pk_fma_f32 v[142:143], v[136:137], s[40:41], v[134:135] op_sel_hi:[1,0,1] neg_lo:[1,0,0] neg_hi:[1,0,0]
    v_pk_fma_f32 v[146:147], v[136:137], s[40:41], v[134:135] op_sel_hi:[1,0,1] neg_lo:[1,0,1] neg_hi:[1,0,1]
    v_cvt_pk_bf16_f32 v52, v140, v142
    v_cvt_pk_bf16_f32 v53, v141, v143
    v_cvt_pk_bf16_f32 v60, v144, v146
    v_cvt_pk_bf16_f32 v61, v145, v147
    v_pk_add_f32 v[148:149], v[198:199], v[38:39]
    v_pk_add_f32 v[150:151], v[214:215], v[46:47]
    v_pk_add_f32 v[152:153], v[198:199], v[38:39] neg_lo:[0,1] neg_hi:[0,1]
    v_pk_add_f32 v[154:155], v[214:215], v[46:47] neg_lo:[0,1] neg_hi:[0,1]
    v_pk_fma_f32 v[156:157], v[154:155], s[42:43], v[148:149] op_sel_hi:[1,0,1]
    v_pk_fma_f32 v[160:161], v[154:155], s[42:43], v[148:149] op_sel_hi:[1,0,1] neg_lo:[1,0,0] neg_hi:[1,0,0]
    v_pk_fma_f32 v[158:159], v[152:153], s[40:41], v[150:151] op_sel_hi:[1,0,1] neg_lo:[1,0,0] neg_hi:[1,0,0]
    v_pk_fma_f32 v[162:163], v[152:153], s[40:41], v[150:151] op_sel_hi:[1,0,1] neg_lo:[1,0,1] neg_hi:[1,0,1]
    v_cvt_pk_bf16_f32 v54, v156, v158
    v_cvt_pk_bf16_f32 v55, v157, v159
    v_cvt_pk_bf16_f32 v62, v160, v162
    v_cvt_pk_bf16_f32 v63, v161, v163
    v_pk_add_f32 v[132:133], v[200:201], v[40:41]
    v_pk_add_f32 v[134:135], v[216:217], v[48:49]
    v_pk_add_f32 v[136:137], v[200:201], v[40:41] neg_lo:[0,1] neg_hi:[0,1]
    v_pk_add_f32 v[138:139], v[216:217], v[48:49] neg_lo:[0,1] neg_hi:[0,1]
    v_pk_fma_f32 v[140:141], v[138:139], s[42:43], v[132:133] op_sel_hi:[1,0,1]
    v_pk_fma_f32 v[144:145], v[138:139], s[42:43], v[132:133] op_sel_hi:[1,0,1] neg_lo:[1,0,0] neg_hi:[1,0,0]
    v_pk_fma_f32 v[142:143], v[136:137], s[40:41], v[134:135] op_sel_hi:[1,0,1] neg_lo:[1,0,0] neg_hi:[1,0,0]
    v_pk_fma_f32 v[146:147], v[136:137], s[40:41], v[134:135] op_sel_hi:[1,0,1] neg_lo:[1,0,1] neg_hi:[1,0,1]
    v_cvt_pk_bf16_f32 v56, v140, v142
    v_cvt_pk_bf16_f32 v57, v141, v143
    v_cvt_pk_bf16_f32 v64, v144, v146
    v_cvt_pk_bf16_f32 v65, v145, v147
    v_pk_add_f32 v[148:149], v[202:203], v[42:43]
    v_pk_add_f32 v[150:151], v[218:219], v[50:51]
    v_pk_add_f32 v[152:153], v[202:203], v[42:43] neg_lo:[0,1] neg_hi:[0,1]
    v_pk_add_f32 v[154:155], v[218:219], v[50:51] neg_lo:[0,1] neg_hi:[0,1]
    v_pk_fma_f32 v[156:157], v[154:155], s[42:43], v[148:149] op_sel_hi:[1,0,1]
    v_pk_fma_f32 v[160:161], v[154:155], s[42:43], v[148:149] op_sel_hi:[1,0,1] neg_lo:[1,0,0] neg_hi:[1,0,0]
    v_pk_fma_f32 v[158:159], v[152:153], s[40:41], v[150:151] op_sel_hi:[1,0,1] neg_lo:[1,0,0] neg_hi:[1,0,0]
    v_pk_fma_f32 v[162:163], v[152:153], s[40:41], v[150:151] op_sel_hi:[1,0,1] neg_lo:[1,0,1] neg_hi:[1,0,1]
    v_cvt_pk_bf16_f32 v58, v156, v158
    v_cvt_pk_bf16_f32 v59, v157, v159
    v_cvt_pk_bf16_f32 v66, v160, v162
    v_cvt_pk_bf16_f32 v67, v161, v163
    s_branch L_p2_postd
L_p2_spost:
    v_pk_add_f32 v[132:133], v[196:197], v[36:37]
    v_pk_add_f32 v[134:135], v[212:213], v[44:45]
    v_pk_add_f32 v[136:137], v[196:197], v[36:37] neg_lo:[0,1] neg_hi:[0,1]
    v_pk_add_f32 v[138:139], v[212:213], v[44:45] neg_lo:[0,1] neg_hi:[0,1]
    v_pk_mul_f32 v[142:143], v[136:137], s[40:41] op_sel_hi:[1,0] neg_lo:[1,0] neg_hi:[1,0]
    v_pk_mul_f32 v[146:147], v[138:139], s[40:41] op_sel_hi:[1,0]
    v_cvt_pk_bf16_f32 v52, v132, v142
    v_cvt_pk_bf16_f32 v53, v133, v143
    v_cvt_pk_bf16_f32 v60, -v134, v146
    v_cvt_pk_bf16_f32 v61, -v135, v147
    v_pk_add_f32 v[148:149], v[198:199], v[38:39]
    v_pk_add_f32 v[150:151], v[214:215], v[46:47]
    v_pk_add_f32 v[152:153], v[198:199], v[38:39] neg_lo:[0,1] neg_hi:[0,1]
    v_pk_add_f32 v[154:155], v[214:215], v[46:47] neg_lo:[0,1] neg_hi:[0,1]
    v_pk_mul_f32 v[158:159], v[152:153], s[40:41] op_sel_hi:[1,0] neg_lo:[1,0] neg_hi:[1,0]
    v_pk_mul_f32 v[162:163], v[154:155], s[40:41] op_sel_hi:[1,0]
    v_cvt_pk_bf16_f32 v54, v148, v158
    v_cvt_pk_bf16_f32 v55, v149, v159
    v_cvt_pk_bf16_f32 v62, -v150, v162
    v_cvt_pk_bf16_f32 v63, -v151, v163
    v_pk_add_f32 v[132:133], v[200:201], v[40:41]
    v_pk_add_f32 v[134:135], v[216:217], v[48:49]
    v_pk_add_f32 v[136:137], v[200:201], v[40:41] neg_lo:[0,1] neg_hi:[0,1]
    v_pk_add_f32 v[138:139], v[216:217], v[48:49] neg_lo:[0,1] neg_hi:[0,1]
    v_pk_mul_f32 v[142:143], v[136:137], s[40:41] op_sel_hi:[1,0] neg_lo:[1,0] neg_hi:[1,0]
    v_pk_mul_f32 v[146:147], v[138:139], s[40:41] op_sel_hi:[1,0]
    v_cvt_pk_bf16_f32 v56, v132, v142
    v_cvt_pk_bf16_f32 v57, v133, v143
    v_cvt_pk_bf16_f32 v64, -v134, v146
    v_cvt_pk_bf16_f32 v65, -v135, v147
    v_pk_add_f32 v[148:149], v[202:203], v[42:43]
    v_pk_add_f32 v[150:151], v[218:219], v[50:51]
    v_pk_add_f32 v[152:153], v[202:203], v[42:43] neg_lo:[0,1] neg_hi:[0,1]
    v_pk_add_f32 v[154:155], v[218:219], v[50:51] neg_lo:[0,1] neg_hi:[0,1]
    v_pk_mul_f32 v[158:159], v[152:153], s[40:41] op_sel_hi:[1,0] neg_lo:[1,0] neg_hi:[1,0]
    v_pk_mul_f32 v[162:163], v[154:155], s[40:41] op_sel_hi:[1,0]
    v_cvt_pk_bf16_f32 v58, v148, v158
    v_cvt_pk_bf16_f32 v59, v149, v159
    v_cvt_pk_bf16_f32 v66, -v150, v162
    v_cvt_pk_bf16_f32 v67, -v151, v163
L_p2_postd:
    ds_write_b128 v253, v[52:55] offset:0
    ds_write_b128 v254, v[60:63] offset:0
    ds_write_b128 v253, v[56:59] offset:4096
    ds_write_b128 v254, v[64:67] offset:4096
    v_and_b32 v228, 3, v0
    v_bfe_u32 v229, v0, 3, 2
    v_xor_b32 v229, v228, v229
    v_lshrrev_b32 v230, 2, v0
    v_lshlrev_b32 v231, 6, v230
    v_lshl_add_u32 v231, v229, 4, v231
    v_add_u32 v231, 49152, v231
    v_mul_u32_u24 v230, 16384, v230
    s_and_b32 s44, s2, 2
    v_xor_b32 v228, s44, v228
    v_lshl_add_u32 v230, v228, 4, v230
    s_lshl_b32 s45, s2, 6
    s_waitcnt lgkmcnt(0)
    s_barrier
    ds_read_b128 v[4:7], v231 offset:0
    ds_read_b128 v[8:11], v231 offset:4096
    ds_read_b128 v[12:15], v231 offset:8192
    ds_read_b128 v[16:19], v231 offset:12288
    s_waitcnt lgkmcnt(0)
    buffer_store_dwordx4 v[4:7], v230, s[12:15], s45 offen sc1
    s_add_u32 s45, s45, 1048576
    buffer_store_dwordx4 v[8:11], v230, s[12:15], s45 offen sc1
    s_add_u32 s45, s45, 1048576
    buffer_store_dwordx4 v[12:15], v230, s[12:15], s45 offen sc1
    s_add_u32 s45, s45, 1048576
    buffer_store_dwordx4 v[16:19], v230, s[12:15], s45 offen sc1
    s_lshr_b32 s29, s2, 5
    s_lshl_b32 s29, s29, 2
    s_and_b32 s30, s2, 31
    s_add_u32 s31, s29, s28
    s_lshl_b32 s31, s31, 5
    s_add_u32 s31, s31, s30
    s_lshl_b32 s31, s31, 11
    s_add_u32 s32, s31, 0x200000
    s_mul_i32 s33, s2, 16384
    s_lshl_b32 s34, s28, 12
    s_add_u32 s33, s33, s34
    v_lshlrev_b32 v2, 4, v1
    s_mov_b32 s8, s4
    s_mov_b32 s9, s5
    s_mov_b32 s10, 0x400000
    s_mov_b32 s11, 0x20000
    s_add_u32 s16, s26, 0xe00000
    s_addc_u32 s17, s27, 0
    s_mov_b32 s18, 0x400000
    s_mov_b32 s19, 0x20000
    s_add_u32 s20, s26, 0x1200000
    s_addc_u32 s21, s27, 0
    s_mov_b32 s22, 0x400000
    s_mov_b32 s23, 0x20000
    v_lshlrev_b32 v255, 4, v1
    buffer_load_dwordx4 v[36:39], v255, s[8:11], s31 offen
    buffer_load_dwordx4 v[40:43], v255, s[8:11], s31 offen offset:1024
    buffer_load_dwordx4 v[44:47], v255, s[8:11], s32 offen
    buffer_load_dwordx4 v[48:51], v255, s[8:11], s32 offen offset:1024
    s_cmp_eq_u32 s28, 0
    s_cbranch_scc0 L_p3_nonp
    s_getpc_b64 s[40:41]
L_p3_npc:
    s_add_u32 s40, s40, L_g1_entry-L_p3_npc
    s_addc_u32 s41, s41, 0
    s_lshr_b32 s42, s2, 3
    s_mul_i32 s42, s42, ((L_gbar-L_g1_entry)/128+32)/32
    v_add_u32 v246, s42, v1
    v_lshlrev_b32 v246, 7, v246
    v_mov_b32 v245, s41
    v_add_co_u32 v244, vcc, s40, v246
    s_nop 1
    v_addc_co_u32 v245, vcc, 0, v245, vcc
    v_cmp_gt_u32 vcc, ((L_gbar-L_g1_entry)/128+32)/32, v1
    s_nop 0
    s_mov_b64 exec, vcc
    v_cmp_gt_u32 vcc, L_gbar-L_g1_entry, v246
    s_nop 0
    s_and_b64 exec, exec, vcc
    s_cbranch_execz L_p3_npe
    global_load_dword v247, v[244:245], off
L_p3_npe:
    s_mov_b64 exec, -1
L_p3_nonp:
    v_and_b32 v251, 31, v1
    v_cvt_f32_u32 v251, v251
    v_lshrrev_b32 v252, 5, v1
    v_lshlrev_b32 v252, 2, v252
    v_cvt_f32_u32 v252, v252
    v_mul_f32 v253, 0x3a800000, v251
    v_mul_f32 v254, v253, v252
    v_mul_f32 v232, 0x40a00000, v253
    v_cos_f32 v228, v253
    v_sin_f32 v229, v253
    v_cos_f32 v230, v232
    v_sin_f32 v231, v232
    v_cos_f32 v164, v254
    v_sin_f32_e64 v165, -v254
    v_mul_f32 v164, 0x34b504f3, v164
    v_mul_f32 v165, 0x34b504f3, v165
    v_pk_mul_f32 v[232:233], v[164:165], v[228:229] op_sel_hi:[1,0]
    v_pk_fma_f32 v[166:167], v[164:165], v[228:229], v[232:233] op_sel:[1,1,0] op_sel_hi:[0,1,1] neg_hi:[0,1,0]
    v_pk_mul_f32 v[232:233], v[166:167], v[228:229] op_sel_hi:[1,0]
    v_pk_fma_f32 v[168:169], v[166:167], v[228:229], v[232:233] op_sel:[1,1,0] op_sel_hi:[0,1,1] neg_hi:[0,1,0]
    v_pk_mul_f32 v[232:233], v[168:169], v[228:229] op_sel_hi:[1,0]
    v_pk_fma_f32 v[170:171], v[168:169], v[228:229], v[232:233] op_sel:[1,1,0] op_sel_hi:[0,1,1] neg_hi:[0,1,0]
    v_pk_mul_f32 v[232:233], v[170:171], v[230:231] op_sel_hi:[1,0]
    v_pk_fma_f32 v[172:173], v[170:171], v[230:231], v[232:233] op_sel:[1,1,0] op_sel_hi:[0,1,1] neg_hi:[0,1,0]
    v_pk_mul_f32 v[232:233], v[172:173], v[228:229] op_sel_hi:[1,0]
    v_pk_fma_f32 v[174:175], v[172:173], v[228:229], v[232:233] op_sel:[1,1,0] op_sel_hi:[0,1,1] neg_hi:[0,1,0]
    v_pk_mul_f32 v[232:233], v[174:175], v[228:229] op_sel_hi:[1,0]
    v_pk_fma_f32 v[176:177], v[174:175], v[228:229], v[232:233] op_sel:[1,1,0] op_sel_hi:[0,1,1] neg_hi:[0,1,0]
    v_pk_mul_f32 v[232:233], v[176:177], v[228:229] op_sel_hi:[1,0]
    v_pk_fma_f32 v[178:179], v[176:177], v[228:229], v[232:233] op_sel:[1,1,0] op_sel_hi:[0,1,1] neg_hi:[0,1,0]
    v_pk_mul_f32 v[232:233], v[178:179], v[230:231] op_sel_hi:[1,0]
    v_pk_fma_f32 v[180:181], v[178:179], v[230:231], v[232:233] op_sel:[1,1,0] op_sel_hi:[0,1,1] neg_hi:[0,1,0]
    v_pk_mul_f32 v[232:233], v[180:181], v[228:229] op_sel_hi:[1,0]
    v_pk_fma_f32 v[182:183], v[180:181], v[228:229], v[232:233] op_sel:[1,1,0] op_sel_hi:[0,1,1] neg_hi:[0,1,0]
    v_pk_mul_f32 v[232:233], v[182:183], v[228:229] op_sel_hi:[1,0]
    v_pk_fma_f32 v[184:185], v[182:183], v[228:229], v[232:233] op_sel:[1,1,0] op_sel_hi:[0,1,1] neg_hi:[0,1,0]
    v_pk_mul_f32 v[232:233], v[184:185], v[228:229] op_sel_hi:[1,0]
    v_pk_fma_f32 v[186:187], v[184:185], v[228:229], v[232:233] op_sel:[1,1,0] op_sel_hi:[0,1,1] neg_hi:[0,1,0]
    v_pk_mul_f32 v[232:233], v[186:187], v[230:231] op_sel_hi:[1,0]
    v_pk_fma_f32 v[188:189], v[186:187], v[230:231], v[232:233] op_sel:[1,1,0] op_sel_hi:[0,1,1] neg_hi:[0,1,0]
    v_pk_mul_f32 v[232:233], v[188:189], v[228:229] op_sel_hi:[1,0]
    v_pk_fma_f32 v[190:191], v[188:189], v[228:229], v[232:233] op_sel:[1,1,0] op_sel_hi:[0,1,1] neg_hi:[0,1,0]
    v_pk_mul_f32 v[232:233], v[190:191], v[228:229] op_sel_hi:[1,0]
    v_pk_fma_f32 v[192:193], v[190:191], v[228:229], v[232:233] op_sel:[1,1,0] op_sel_hi:[0,1,1] neg_hi:[0,1,0]
    v_pk_mul_f32 v[232:233], v[192:193], v[228:229] op_sel_hi:[1,0]
    v_pk_fma_f32 v[194:195], v[192:193], v[228:229], v[232:233] op_sel:[1,1,0] op_sel_hi:[0,1,1] neg_hi:[0,1,0]
    v_and_b32 v2, 31, v1
    v_lshrrev_b32 v3, 5, v1
    v_and_b32 v251, 1, v2
    v_lshrrev_b32 v252, 1, v2
    v_and_b32 v248, 2, v252
    v_xor_b32 v248, v248, v251
    v_lshlrev_b32 v248, 4, v248
    v_lshl_add_u32 v248, v252, 6, v248
    v_lshl_add_u32 v248, v3, 12, v248
    s_lshl_b32 s37, s28, 2
    v_add_u32 v248, s37, v248
    v_add_u32 v252, 1, v2
    v_lshrrev_b32 v252, 1, v252
    v_sub_u32 v249, 0, v252
    v_and_b32 v249, 2, v249
    v_add_u32 v251, 2, v251
    v_xor_b32 v249, v249, v251
    v_lshlrev_b32 v249, 4, v249
    v_lshlrev_b32 v252, 6, v252
    v_sub_u32 v249, v249, v252
    v_lshlrev_b32 v252, 12, v3
    v_sub_u32 v249, v249, v252
    s_add_u32 s37, s37, 5120
    v_add_u32 v249, s37, v249
    v_add_u32 v250, 11264, v249
    s_lshl_b32 s38, s28, 2
    s_add_u32 s38, s38, 32
    v_mov_b32 v253, s38
    v_cmp_eq_u32 vcc, 0, v1
    s_nop 1
    v_cndmask_b32 v250, v250, v253, vcc
    s_mov_b32 s35, 0xffff0000
    v_lshlrev_b32 v2, 4, v1
    s_mov_b32 s41, 0
    s_waitcnt vmcnt(0)
L_p3_poll:
    s_add_u32 s39, s33, 0
    buffer_load_dwordx4 v[20:23], v2, s[12:15], s39 offen sc0 sc1
    s_add_u32 s39, s33, 1024
    buffer_load_dwordx4 v[24:27], v2, s[12:15], s39 offen sc0 sc1
    s_add_u32 s39, s33, 2048
    buffer_load_dwordx4 v[28:31], v2, s[12:15], s39 offen sc0 sc1
    s_add_u32 s39, s33, 3072
    buffer_load_dwordx4 v[32:35], v2, s[12:15], s39 offen sc0 sc1
    s_add_u32 s41, s41, 1
    s_waitcnt vmcnt(0)
    v_max3_u32 v3, v20, v21, v22
    v_max3_u32 v3, v3, v23, v24
    v_max3_u32 v3, v3, v25, v26
    v_max3_u32 v3, v3, v27, v28
    v_max3_u32 v3, v3, v29, v30
    v_max3_u32 v3, v3, v31, v32
    v_max3_u32 v3, v3, v33, v34
    v_max_u32 v3, v3, v35
    v_cmp_eq_u32 vcc, -1, v3
    s_nop 4
    s_cmp_ge_u32 s41, 0x20000
    s_cbranch_scc1 L_p3_polld
    s_cbranch_vccnz L_p3_poll
L_p3_polld:
    v_add_u32 v2, s34, v2
    ds_write_b128 v2, v[20:23] offset:0
    ds_write_b128 v2, v[24:27] offset:1024
    ds_write_b128 v2, v[28:31] offset:2048
    ds_write_b128 v2, v[32:35] offset:3072
    s_waitcnt lgkmcnt(0)
    s_barrier
    ds_read_b32 v20, v248 offset:0
    ds_read_b32 v21, v248 offset:1024
    ds_read_b32 v22, v248 offset:2048
    ds_read_b32 v23, v248 offset:3072
    ds_read_b32 v24, v248 offset:8192
    ds_read_b32 v25, v248 offset:9216
    ds_read_b32 v26, v248 offset:10240
    ds_read_b32 v27, v248 offset:11264
    ds_read_b32 v28, v250
    ds_read_b32 v29, v249 offset:10240
    ds_read_b32 v30, v249 offset:9216
    ds_read_b32 v31, v249 offset:8192
    ds_read_b32 v32, v249 offset:3072
    ds_read_b32 v33, v249 offset:2048
    ds_read_b32 v34, v249 offset:1024
    ds_read_b32 v35, v249 offset:0
    s_waitcnt lgkmcnt(0)
    v_mfma_f32_32x32x16_bf16 v[196:211], v[20:23], v[68:71], 0
    v_mfma_f32_32x32x16_bf16 v[212:227], v[20:23], v[84:87], 0
    v_mfma_f32_32x32x16_bf16 v[196:211], v[24:27], v[72:75], v[196:211]
    v_mfma_f32_32x32x16_bf16 v[212:227], v[24:27], v[88:91], v[212:227]
    v_mfma_f32_32x32x16_bf16 v[196:211], v[28:31], v[76:79], v[196:211]
    v_mfma_f32_32x32x16_bf16 v[212:227], v[28:31], v[92:95], v[212:227]
    v_mfma_f32_32x32x16_bf16 v[196:211], v[32:35], v[80:83], v[196:211]
    v_mfma_f32_32x32x16_bf16 v[212:227], v[32:35], v[96:99], v[212:227]
    s_nop 10
    v_pk_mul_f32 v[228:229], v[164:165], v[196:197] op_sel:[0,0] op_sel_hi:[1,0]
    v_pk_fma_f32 v[228:229], v[164:165], v[212:213], v[228:229] op_sel:[1,0,0] op_sel_hi:[0,0,1] neg_lo:[1,0,0]
    v_pk_mul_f32 v[230:231], v[166:167], v[196:197] op_sel:[0,1] op_sel_hi:[1,1]
    v_pk_fma_f32 v[230:231], v[166:167], v[212:213], v[230:231] op_sel:[1,1,0] op_sel_hi:[0,1,1] neg_lo:[1,0,0]
    v_cvt_pk_bf16_f32 v20, v228, v229
    v_pk_mul_f32 v[232:233], v[168:169], v[198:199] op_sel:[0,0] op_sel_hi:[1,0]
    v_pk_fma_f32 v[232:233], v[168:169], v[214:215], v[232:233] op_sel:[1,0,0] op_sel_hi:[0,0,1] neg_lo:[1,0,0]
    v_cvt_pk_bf16_f32 v21, v230, v231
    v_pk_mul_f32 v[234:235], v[170:171], v[198:199] op_sel:[0,1] op_sel_hi:[1,1]
    v_pk_fma_f32 v[234:235], v[170:171], v[214:215], v[234:235] op_sel:[1,1,0] op_sel_hi:[0,1,1] neg_lo:[1,0,0]
    v_cvt_pk_bf16_f32 v22, v232, v233
    v_pk_mul_f32 v[228:229], v[172:173], v[200:201] op_sel:[0,0] op_sel_hi:[1,0]
    v_pk_fma_f32 v[228:229], v[172:173], v[216:217], v[228:229] op_sel:[1,0,0] op_sel_hi:[0,0,1] neg_lo:[1,0,0]
    v_cvt_pk_bf16_f32 v23, v234, v235
    v_pk_mul_f32 v[230:231], v[174:175], v[200:201] op_sel:[0,1] op_sel_hi:[1,1]
    v_pk_fma_f32 v[230:231], v[174:175], v[216:217], v[230:231] op_sel:[1,1,0] op_sel_hi:[0,1,1] neg_lo:[1,0,0]
    v_cvt_pk_bf16_f32 v24, v228, v229
    v_pk_mul_f32 v[232:233], v[176:177], v[202:203] op_sel:[0,0] op_sel_hi:[1,0]
    v_pk_fma_f32 v[232:233], v[176:177], v[218:219], v[232:233] op_sel:[1,0,0] op_sel_hi:[0,0,1] neg_lo:[1,0,0]
    v_cvt_pk_bf16_f32 v25, v230, v231
    v_pk_mul_f32 v[234:235], v[178:179], v[202:203] op_sel:[0,1] op_sel_hi:[1,1]
    v_pk_fma_f32 v[234:235], v[178:179], v[218:219], v[234:235] op_sel:[1,1,0] op_sel_hi:[0,1,1] neg_lo:[1,0,0]
    v_cvt_pk_bf16_f32 v26, v232, v233
    v_pk_mul_f32 v[228:229], v[180:181], v[204:205] op_sel:[0,0] op_sel_hi:[1,0]
    v_pk_fma_f32 v[228:229], v[180:181], v[220:221], v[228:229] op_sel:[1,0,0] op_sel_hi:[0,0,1] neg_lo:[1,0,0]
    v_cvt_pk_bf16_f32 v27, v234, v235
    v_pk_mul_f32 v[230:231], v[182:183], v[204:205] op_sel:[0,1] op_sel_hi:[1,1]
    v_pk_fma_f32 v[230:231], v[182:183], v[220:221], v[230:231] op_sel:[1,1,0] op_sel_hi:[0,1,1] neg_lo:[1,0,0]
    v_cvt_pk_bf16_f32 v28, v228, v229
    v_pk_mul_f32 v[232:233], v[184:185], v[206:207] op_sel:[0,0] op_sel_hi:[1,0]
    v_pk_fma_f32 v[232:233], v[184:185], v[222:223], v[232:233] op_sel:[1,0,0] op_sel_hi:[0,0,1] neg_lo:[1,0,0]
    v_cvt_pk_bf16_f32 v29, v230, v231
    v_pk_mul_f32 v[234:235], v[186:187], v[206:207] op_sel:[0,1] op_sel_hi:[1,1]
    v_pk_fma_f32 v[234:235], v[186:187], v[222:223], v[234:235] op_sel:[1,1,0] op_sel_hi:[0,1,1] neg_lo:[1,0,0]
    v_cvt_pk_bf16_f32 v30, v232, v233
    v_pk_mul_f32 v[228:229], v[188:189], v[208:209] op_sel:[0,0] op_sel_hi:[1,0]
    v_pk_fma_f32 v[228:229], v[188:189], v[224:225], v[228:229] op_sel:[1,0,0] op_sel_hi:[0,0,1] neg_lo:[1,0,0]
    v_cvt_pk_bf16_f32 v31, v234, v235
    v_pk_mul_f32 v[230:231], v[190:191], v[208:209] op_sel:[0,1] op_sel_hi:[1,1]
    v_pk_fma_f32 v[230:231], v[190:191], v[224:225], v[230:231] op_sel:[1,1,0] op_sel_hi:[0,1,1] neg_lo:[1,0,0]
    v_cvt_pk_bf16_f32 v32, v228, v229
    v_pk_mul_f32 v[232:233], v[192:193], v[210:211] op_sel:[0,0] op_sel_hi:[1,0]
    v_pk_fma_f32 v[232:233], v[192:193], v[226:227], v[232:233] op_sel:[1,0,0] op_sel_hi:[0,0,1] neg_lo:[1,0,0]
    v_cvt_pk_bf16_f32 v33, v230, v231
    v_pk_mul_f32 v[234:235], v[194:195], v[210:211] op_sel:[0,1] op_sel_hi:[1,1]
    v_pk_fma_f32 v[234:235], v[194:195], v[226:227], v[234:235] op_sel:[1,1,0] op_sel_hi:[0,1,1] neg_lo:[1,0,0]
    v_cvt_pk_bf16_f32 v34, v232, v233
    v_cvt_pk_bf16_f32 v35, v234, v235
    v_mfma_f32_32x32x16_bf16 v[196:211], v[68:71], v[20:23], 0
    v_mfma_f32_32x32x16_bf16 v[212:227], v[84:87], v[20:23], 0
    v_mfma_f32_32x32x16_bf16 v[196:211], v[72:75], v[24:27], v[196:211]
    v_mfma_f32_32x32x16_bf16 v[212:227], v[88:91], v[24:27], v[212:227]
    v_mfma_f32_32x32x16_bf16 v[196:211], v[76:79], v[28:31], v[196:211]
    v_mfma_f32_32x32x16_bf16 v[212:227], v[92:95], v[28:31], v[212:227]
    v_mfma_f32_32x32x16_bf16 v[196:211], v[80:83], v[32:35], v[196:211]
    v_mfma_f32_32x32x16_bf16 v[212:227], v[96:99], v[32:35], v[212:227]
    v_lshlrev_b32 v100, 16, v36
    v_and_b32 v101, s35, v36
    v_lshlrev_b32 v116, 16, v44
    v_and_b32 v117, s35, v44
    v_lshlrev_b32 v102, 16, v37
    v_and_b32 v103, s35, v37
    v_lshlrev_b32 v118, 16, v45
    v_and_b32 v119, s35, v45
    v_lshlrev_b32 v104, 16, v38
    v_and_b32 v105, s35, v38
    v_lshlrev_b32 v120, 16, v46
    v_and_b32 v121, s35, v46
    v_lshlrev_b32 v106, 16, v39
    v_and_b32 v107, s35, v39
    v_lshlrev_b32 v122, 16, v47
    v_and_b32 v123, s35, v47
    v_lshlrev_b32 v108, 16, v40
    v_and_b32 v109, s35, v40
    v_lshlrev_b32 v124, 16, v48
    v_and_b32 v125, s35, v48
    v_lshlrev_b32 v110, 16, v41
    v_and_b32 v111, s35, v41
    v_lshlrev_b32 v126, 16, v49
    v_and_b32 v127, s35, v49
    v_lshlrev_b32 v112, 16, v42
    v_and_b32 v113, s35, v42
    v_lshlrev_b32 v128, 16, v50
    v_and_b32 v129, s35, v50
    v_lshlrev_b32 v114, 16, v43
    v_and_b32 v115, s35, v43
    v_lshlrev_b32 v130, 16, v51
    v_and_b32 v131, s35, v51
    s_lshl_b32 s36, s28, 12
    s_add_u32 s36, s36, 17408
    v_and_b32 v3, 31, v1
    v_lshlrev_b32 v3, 2, v3
    v_lshrrev_b32 v251, 5, v1
    v_lshlrev_b32 v251, 9, v251
    v_add3_u32 v3, v3, v251, s36
    v_lshl_add_u32 v2, v1, 5, s36
    v_cvt_pk_bf16_f32 v20, v196, -v212
    v_cvt_pk_bf16_f32 v21, v197, -v213
    v_cvt_pk_bf16_f32 v22, v198, -v214
    v_cvt_pk_bf16_f32 v23, v199, -v215
    v_cvt_pk_bf16_f32 v24, v200, -v216
    v_cvt_pk_bf16_f32 v25, v201, -v217
    v_cvt_pk_bf16_f32 v26, v202, -v218
    v_cvt_pk_bf16_f32 v27, v203, -v219
    v_cvt_pk_bf16_f32 v28, v204, -v220
    v_cvt_pk_bf16_f32 v29, v205, -v221
    v_cvt_pk_bf16_f32 v30, v206, -v222
    v_cvt_pk_bf16_f32 v31, v207, -v223
    v_cvt_pk_bf16_f32 v32, v208, -v224
    v_cvt_pk_bf16_f32 v33, v209, -v225
    v_cvt_pk_bf16_f32 v34, v210, -v226
    v_cvt_pk_bf16_f32 v35, v211, -v227
    ds_write_b32 v3, v20 offset:0
    ds_write_b32 v3, v21 offset:128
    ds_write_b32 v3, v22 offset:256
    ds_write_b32 v3, v23 offset:384
    ds_write_b32 v3, v24 offset:1024
    ds_write_b32 v3, v25 offset:1152
    ds_write_b32 v3, v26 offset:1280
    ds_write_b32 v3, v27 offset:1408
    ds_write_b32 v3, v28 offset:2048
    ds_write_b32 v3, v29 offset:2176
    ds_write_b32 v3, v30 offset:2304
    ds_write_b32 v3, v31 offset:2432
    ds_write_b32 v3, v32 offset:3072
    ds_write_b32 v3, v33 offset:3200
    ds_write_b32 v3, v34 offset:3328
    ds_write_b32 v3, v35 offset:3456
    s_waitcnt lgkmcnt(0)
    ds_read_b128 v[20:23], v2
    ds_read_b128 v[24:27], v2 offset:16
    ds_read_b128 v[28:31], v2 offset:2048
    ds_read_b128 v[32:35], v2 offset:2064
    s_waitcnt lgkmcnt(0)
    v_lshlrev_b32 v132, 16, v20
    v_and_b32 v148, s35, v20
    v_lshlrev_b32 v133, 16, v21
    v_and_b32 v149, s35, v21
    v_lshlrev_b32 v134, 16, v22
    v_and_b32 v150, s35, v22
    v_lshlrev_b32 v135, 16, v23
    v_and_b32 v151, s35, v23
    v_lshlrev_b32 v136, 16, v24
    v_and_b32 v152, s35, v24
    v_lshlrev_b32 v137, 16, v25
    v_and_b32 v153, s35, v25
    v_lshlrev_b32 v138, 16, v26
    v_and_b32 v154, s35, v26
    v_lshlrev_b32 v139, 16, v27
    v_and_b32 v155, s35, v27
    v_lshlrev_b32 v140, 16, v28
    v_and_b32 v156, s35, v28
    v_lshlrev_b32 v141, 16, v29
    v_and_b32 v157, s35, v29
    v_lshlrev_b32 v142, 16, v30
    v_and_b32 v158, s35, v30
    v_lshlrev_b32 v143, 16, v31
    v_and_b32 v159, s35, v31
    v_lshlrev_b32 v144, 16, v32
    v_and_b32 v160, s35, v32
    v_lshlrev_b32 v145, 16, v33
    v_and_b32 v161, s35, v33
    v_lshlrev_b32 v146, 16, v34
    v_and_b32 v162, s35, v34
    v_lshlrev_b32 v147, 16, v35
    v_and_b32 v163, s35, v35
    v_pk_add_f32 v[132:133], v[132:133], v[100:101]
    v_pk_add_f32 v[148:149], v[148:149], v[116:117]
    v_pk_add_f32 v[134:135], v[134:135], v[102:103]
    v_pk_add_f32 v[150:151], v[150:151], v[118:119]
    v_pk_add_f32 v[136:137], v[136:137], v[104:105]
    v_pk_add_f32 v[152:153], v[152:153], v[120:121]
    v_pk_add_f32 v[138:139], v[138:139], v[106:107]
    v_pk_add_f32 v[154:155], v[154:155], v[122:123]
    v_pk_add_f32 v[140:141], v[140:141], v[108:109]
    v_pk_add_f32 v[156:157], v[156:157], v[124:125]
    v_pk_add_f32 v[142:143], v[142:143], v[110:111]
    v_pk_add_f32 v[158:159], v[158:159], v[126:127]
    v_pk_add_f32 v[144:145], v[144:145], v[112:113]
    v_pk_add_f32 v[160:161], v[160:161], v[128:129]
    v_pk_add_f32 v[146:147], v[146:147], v[114:115]
    v_pk_add_f32 v[162:163], v[162:163], v[130:131]
    v_cvt_pk_bf16_f32 v52, v132, v133
    v_cvt_pk_bf16_f32 v60, v148, v149
    v_cvt_pk_bf16_f32 v53, v134, v135
    v_cvt_pk_bf16_f32 v61, v150, v151
    v_cvt_pk_bf16_f32 v54, v136, v137
    v_cvt_pk_bf16_f32 v62, v152, v153
    v_cvt_pk_bf16_f32 v55, v138, v139
    v_cvt_pk_bf16_f32 v63, v154, v155
    v_cvt_pk_bf16_f32 v56, v140, v141
    v_cvt_pk_bf16_f32 v64, v156, v157
    v_cvt_pk_bf16_f32 v57, v142, v143
    v_cvt_pk_bf16_f32 v65, v158, v159
    v_cvt_pk_bf16_f32 v58, v144, v145
    v_cvt_pk_bf16_f32 v66, v160, v161
    v_cvt_pk_bf16_f32 v59, v146, v147
    v_cvt_pk_bf16_f32 v67, v162, v163
    v_lshlrev_b32 v2, 4, v1
    buffer_store_dwordx4 v[52:55], v2, s[16:19], s31 offen sc1
    buffer_store_dwordx4 v[56:59], v2, s[16:19], s31 offen offset:1024 sc1
    buffer_store_dwordx4 v[60:63], v2, s[16:19], s32 offen sc1
    buffer_store_dwordx4 v[64:67], v2, s[16:19], s32 offen offset:1024 sc1
    v_lshlrev_b32 v100, 16, v52
    v_and_b32 v101, s35, v52
    v_lshlrev_b32 v116, 16, v60
    v_and_b32 v117, s35, v60
    v_lshlrev_b32 v102, 16, v53
    v_and_b32 v103, s35, v53
    v_lshlrev_b32 v118, 16, v61
    v_and_b32 v119, s35, v61
    v_lshlrev_b32 v104, 16, v54
    v_and_b32 v105, s35, v54
    v_lshlrev_b32 v120, 16, v62
    v_and_b32 v121, s35, v62
    v_lshlrev_b32 v106, 16, v55
    v_and_b32 v107, s35, v55
    v_lshlrev_b32 v122, 16, v63
    v_and_b32 v123, s35, v63
    v_lshlrev_b32 v108, 16, v56
    v_and_b32 v109, s35, v56
    v_lshlrev_b32 v124, 16, v64
    v_and_b32 v125, s35, v64
    v_lshlrev_b32 v110, 16, v57
    v_and_b32 v111, s35, v57
    v_lshlrev_b32 v126, 16, v65
    v_and_b32 v127, s35, v65
    v_lshlrev_b32 v112, 16, v58
    v_and_b32 v113, s35, v58
    v_lshlrev_b32 v128, 16, v66
    v_and_b32 v129, s35, v66
    v_lshlrev_b32 v114, 16, v59
    v_and_b32 v115, s35, v59
    v_lshlrev_b32 v130, 16, v67
    v_and_b32 v131, s35, v67
    v_pk_add_f32 v[228:229], v[100:101], v[102:103]
    v_pk_add_f32 v[230:231], v[104:105], v[106:107]
    v_pk_add_f32 v[232:233], v[116:117], v[118:119]
    v_pk_add_f32 v[234:235], v[120:121], v[122:123]
    v_pk_add_f32 v[228:229], v[228:229], v[108:109]
    v_pk_add_f32 v[232:233], v[232:233], v[124:125]
    v_pk_add_f32 v[230:231], v[230:231], v[110:111]
    v_pk_add_f32 v[234:235], v[234:235], v[126:127]
    v_pk_add_f32 v[228:229], v[228:229], v[112:113]
    v_pk_add_f32 v[232:233], v[232:233], v[128:129]
    v_pk_add_f32 v[230:231], v[230:231], v[114:115]
    v_pk_add_f32 v[234:235], v[234:235], v[130:131]
    v_pk_add_f32 v[228:229], v[228:229], v[230:231]
    v_pk_add_f32 v[232:233], v[232:233], v[234:235]
    v_add_f32 v228, v228, v229
    v_add_f32 v229, v232, v233
    s_nop 0
    v_add_f32_dpp v228, v228, v228 quad_perm:[1,0,3,2] row_mask:0xf bank_mask:0xf
    v_add_f32_dpp v229, v229, v229 quad_perm:[1,0,3,2] row_mask:0xf bank_mask:0xf
    s_nop 0
    v_add_f32_dpp v228, v228, v228 quad_perm:[2,3,0,1] row_mask:0xf bank_mask:0xf
    v_add_f32_dpp v229, v229, v229 quad_perm:[2,3,0,1] row_mask:0xf bank_mask:0xf
    s_nop 0
    v_add_f32_dpp v228, v228, v228 row_half_mirror row_mask:0xf bank_mask:0xf
    v_add_f32_dpp v229, v229, v229 row_half_mirror row_mask:0xf bank_mask:0xf
    s_nop 0
    v_add_f32_dpp v228, v228, v228 row_mirror row_mask:0xf bank_mask:0xf
    v_add_f32_dpp v229, v229, v229 row_mirror row_mask:0xf bank_mask:0xf
    s_nop 0
    v_add_f32_dpp v228, v228, v228 row_bcast:15 row_mask:0xa bank_mask:0xf
    v_add_f32_dpp v229, v229, v229 row_bcast:15 row_mask:0xa bank_mask:0xf
    s_nop 0
    v_add_f32_dpp v228, v228, v228 row_bcast:31 row_mask:0xc bank_mask:0xf
    v_add_f32_dpp v229, v229, v229 row_bcast:31 row_mask:0xc bank_mask:0xf
    v_mul_f32 v228, 0x3a800000, v228
    v_mul_f32 v229, 0x3a800000, v229
    v_mov_b32 v240, v228
    v_mov_b32 v241, v229
    v_readlane_b32 s40, v228, 63
    v_readlane_b32 s41, v229, 63
    s_nop 1
    v_pk_add_f32 v[232:233], v[100:101], s[40:41] op_sel_hi:[1,0] neg_lo:[0,1] neg_hi:[0,1]
    v_pk_mul_f32 v[228:229], v[232:233], v[232:233]
    v_pk_add_f32 v[234:235], v[116:117], s[40:41] op_sel:[0,1] op_sel_hi:[1,1] neg_lo:[0,1] neg_hi:[0,1]
    v_pk_mul_f32 v[230:231], v[234:235], v[234:235]
    v_pk_add_f32 v[236:237], v[102:103], s[40:41] op_sel_hi:[1,0] neg_lo:[0,1] neg_hi:[0,1]
    v_pk_fma_f32 v[228:229], v[236:237], v[236:237], v[228:229]
    v_pk_add_f32 v[238:239], v[118:119], s[40:41] op_sel:[0,1] op_sel_hi:[1,1] neg_lo:[0,1] neg_hi:[0,1]
    v_pk_fma_f32 v[230:231], v[238:239], v[238:239], v[230:231]
    v_pk_add_f32 v[232:233], v[104:105], s[40:41] op_sel_hi:[1,0] neg_lo:[0,1] neg_hi:[0,1]
    v_pk_fma_f32 v[228:229], v[232:233], v[232:233], v[228:229]
    v_pk_add_f32 v[234:235], v[120:121], s[40:41] op_sel:[0,1] op_sel_hi:[1,1] neg_lo:[0,1] neg_hi:[0,1]
    v_pk_fma_f32 v[230:231], v[234:235], v[234:235], v[230:231]
    v_pk_add_f32 v[236:237], v[106:107], s[40:41] op_sel_hi:[1,0] neg_lo:[0,1] neg_hi:[0,1]
    v_pk_fma_f32 v[228:229], v[236:237], v[236:237], v[228:229]
    v_pk_add_f32 v[238:239], v[122:123], s[40:41] op_sel:[0,1] op_sel_hi:[1,1] neg_lo:[0,1] neg_hi:[0,1]
    v_pk_fma_f32 v[230:231], v[238:239], v[238:239], v[230:231]
    v_pk_add_f32 v[232:233], v[108:109], s[40:41] op_sel_hi:[1,0] neg_lo:[0,1] neg_hi:[0,1]
    v_pk_fma_f32 v[228:229], v[232:233], v[232:233], v[228:229]
    v_pk_add_f32 v[234:235], v[124:125], s[40:41] op_sel:[0,1] op_sel_hi:[1,1] neg_lo:[0,1] neg_hi:[0,1]
    v_pk_fma_f32 v[230:231], v[234:235], v[234:235], v[230:231]
    v_pk_add_f32 v[236:237], v[110:111], s[40:41] op_sel_hi:[1,0] neg_lo:[0,1] neg_hi:[0,1]
    v_pk_fma_f32 v[228:229], v[236:237], v[236:237], v[228:229]
    v_pk_add_f32 v[238:239], v[126:127], s[40:41] op_sel:[0,1] op_sel_hi:[1,1] neg_lo:[0,1] neg_hi:[0,1]
    v_pk_fma_f32 v[230:231], v[238:239], v[238:239], v[230:231]
    v_pk_add_f32 v[232:233], v[112:113], s[40:41] op_sel_hi:[1,0] neg_lo:[0,1] neg_hi:[0,1]
    v_pk_fma_f32 v[228:229], v[232:233], v[232:233], v[228:229]
    v_pk_add_f32 v[234:235], v[128:129], s[40:41] op_sel:[0,1] op_sel_hi:[1,1] neg_lo:[0,1] neg_hi:[0,1]
    v_pk_fma_f32 v[230:231], v[234:235], v[234:235], v[230:231]
    v_pk_add_f32 v[236:237], v[114:115], s[40:41] op_sel_hi:[1,0] neg_lo:[0,1] neg_hi:[0,1]
    v_pk_fma_f32 v[228:229], v[236:237], v[236:237], v[228:229]
    v_pk_add_f32 v[238:239], v[130:131], s[40:41] op_sel:[0,1] op_sel_hi:[1,1] neg_lo:[0,1] neg_hi:[0,1]
    v_pk_fma_f32 v[230:231], v[238:239], v[238:239], v[230:231]
    v_add_f32 v228, v228, v229
    v_add_f32 v229, v230, v231
    s_nop 0
    v_add_f32_dpp v228, v228, v228 quad_perm:[1,0,3,2] row_mask:0xf bank_mask:0xf
    v_add_f32_dpp v229, v229, v229 quad_perm:[1,0,3,2] row_mask:0xf bank_mask:0xf
    s_nop 0
    v_add_f32_dpp v228, v228, v228 quad_perm:[2,3,0,1] row_mask:0xf bank_mask:0xf
    v_add_f32_dpp v229, v229, v229 quad_perm:[2,3,0,1] row_mask:0xf bank_mask:0xf
    s_nop 0
    v_add_f32_dpp v228, v228, v228 row_half_mirror row_mask:0xf bank_mask:0xf
    v_add_f32_dpp v229, v229, v229 row_half_mirror row_mask:0xf bank_mask:0xf
    s_nop 0
    v_add_f32_dpp v228, v228, v228 row_mirror row_mask:0xf bank_mask:0xf
    v_add_f32_dpp v229, v229, v229 row_mirror row_mask:0xf bank_mask:0xf
    s_nop 0
    v_add_f32_dpp v228, v228, v228 row_bcast:15 row_mask:0xa bank_mask:0xf
    v_add_f32_dpp v229, v229, v229 row_bcast:15 row_mask:0xa bank_mask:0xf
    s_nop 0
    v_add_f32_dpp v228, v228, v228 row_bcast:31 row_mask:0xc bank_mask:0xf
    v_add_f32_dpp v229, v229, v229 row_bcast:31 row_mask:0xc bank_mask:0xf
    v_mul_f32 v228, 0x3a800000, v228
    v_mul_f32 v229, 0x3a800000, v229
    v_add_f32 v230, 0x3727c5ac, v228
    v_add_f32 v231, 0x3727c5ac, v229
    v_rsq_f32 v230, v230
    v_rsq_f32 v231, v231
    s_nop 0
    v_mul_f32 v228, v228, v230
    v_mul_f32 v229, v229, v231
    v_mul_f32 v228, v228, v230
    v_mul_f32 v229, v229, v231
    v_add_f32 v228, 0x3727c5ac, v228
    v_add_f32 v229, 0x3727c5ac, v229
    v_rsq_f32 v228, v228
    v_rsq_f32 v229, v229
    s_nop 0
    v_mul_f32 v228, v228, v230
    v_mul_f32 v229, v229, v231
    v_mul_f32 v240, v240, v228
    v_mul_f32 v241, v241, v229
    v_readlane_b32 s40, v228, 63
    v_readlane_b32 s41, v229, 63
    v_readlane_b32 s42, v240, 63
    v_readlane_b32 s43, v241, 63
    v_mov_b32 v244, s40
    v_mov_b32 v245, s41
    v_mov_b32 v246, s42
    v_mov_b32 v247, s43
    v_pk_fma_f32 v[132:133], v[100:101], v[244:245], v[246:247] op_sel_hi:[1,0,0] neg_lo:[0,0,1] neg_hi:[0,0,1]
    v_pk_fma_f32 v[148:149], v[116:117], v[244:245], v[246:247] op_sel:[0,1,1] op_sel_hi:[1,1,1] neg_lo:[0,0,1] neg_hi:[0,0,1]
    v_pk_fma_f32 v[134:135], v[102:103], v[244:245], v[246:247] op_sel_hi:[1,0,0] neg_lo:[0,0,1] neg_hi:[0,0,1]
    v_pk_fma_f32 v[150:151], v[118:119], v[244:245], v[246:247] op_sel:[0,1,1] op_sel_hi:[1,1,1] neg_lo:[0,0,1] neg_hi:[0,0,1]
    v_pk_fma_f32 v[136:137], v[104:105], v[244:245], v[246:247] op_sel_hi:[1,0,0] neg_lo:[0,0,1] neg_hi:[0,0,1]
    v_pk_fma_f32 v[152:153], v[120:121], v[244:245], v[246:247] op_sel:[0,1,1] op_sel_hi:[1,1,1] neg_lo:[0,0,1] neg_hi:[0,0,1]
    v_pk_fma_f32 v[138:139], v[106:107], v[244:245], v[246:247] op_sel_hi:[1,0,0] neg_lo:[0,0,1] neg_hi:[0,0,1]
    v_pk_fma_f32 v[154:155], v[122:123], v[244:245], v[246:247] op_sel:[0,1,1] op_sel_hi:[1,1,1] neg_lo:[0,0,1] neg_hi:[0,0,1]
    v_pk_fma_f32 v[140:141], v[108:109], v[244:245], v[246:247] op_sel_hi:[1,0,0] neg_lo:[0,0,1] neg_hi:[0,0,1]
    v_pk_fma_f32 v[156:157], v[124:125], v[244:245], v[246:247] op_sel:[0,1,1] op_sel_hi:[1,1,1] neg_lo:[0,0,1] neg_hi:[0,0,1]
    v_pk_fma_f32 v[142:143], v[110:111], v[244:245], v[246:247] op_sel_hi:[1,0,0] neg_lo:[0,0,1] neg_hi:[0,0,1]
    v_pk_fma_f32 v[158:159], v[126:127], v[244:245], v[246:247] op_sel:[0,1,1] op_sel_hi:[1,1,1] neg_lo:[0,0,1] neg_hi:[0,0,1]
    v_pk_fma_f32 v[144:145], v[112:113], v[244:245], v[246:247] op_sel_hi:[1,0,0] neg_lo:[0,0,1] neg_hi:[0,0,1]
    v_pk_fma_f32 v[160:161], v[128:129], v[244:245], v[246:247] op_sel:[0,1,1] op_sel_hi:[1,1,1] neg_lo:[0,0,1] neg_hi:[0,0,1]
    v_pk_fma_f32 v[146:147], v[114:115], v[244:245], v[246:247] op_sel_hi:[1,0,0] neg_lo:[0,0,1] neg_hi:[0,0,1]
    v_pk_fma_f32 v[162:163], v[130:131], v[244:245], v[246:247] op_sel:[0,1,1] op_sel_hi:[1,1,1] neg_lo:[0,0,1] neg_hi:[0,0,1]
    v_cvt_pk_bf16_f32 v4, v132, v133
    v_cvt_pk_bf16_f32 v12, v148, v149
    v_cvt_pk_bf16_f32 v5, v134, v135
    v_cvt_pk_bf16_f32 v13, v150, v151
    v_cvt_pk_bf16_f32 v6, v136, v137
    v_cvt_pk_bf16_f32 v14, v152, v153
    v_cvt_pk_bf16_f32 v7, v138, v139
    v_cvt_pk_bf16_f32 v15, v154, v155
    v_cvt_pk_bf16_f32 v8, v140, v141
    v_cvt_pk_bf16_f32 v16, v156, v157
    v_cvt_pk_bf16_f32 v9, v142, v143
    v_cvt_pk_bf16_f32 v17, v158, v159
    v_cvt_pk_bf16_f32 v10, v144, v145
    v_cvt_pk_bf16_f32 v18, v160, v161
    v_cvt_pk_bf16_f32 v11, v146, v147
    v_cvt_pk_bf16_f32 v19, v162, v163
    buffer_store_dwordx4 v[4:7], v2, s[20:23], s31 offen sc1
    buffer_store_dwordx4 v[8:11], v2, s[20:23], s31 offen offset:1024 sc1
    buffer_store_dwordx4 v[12:15], v2, s[20:23], s32 offen sc1
    buffer_store_dwordx4 v[16:19], v2, s[20:23], s32 offen offset:1024 sc1
    s_waitcnt vmcnt(0)
    s_barrier
    s_add_u32 s16, s26, 0x2830000
    s_addc_u32 s17, s27, 0
    s_mov_b32 s18, 0x8000
    s_mov_b32 s19, 0x20000
    s_lshl_b32 s33, s2, 7
    v_mov_b32 v2, 1
    v_mov_b32 v3, 0
    v_cmp_eq_u32 vcc, 0, v0
    s_nop 0
    s_and_saveexec_b64 s[34:35], vcc
    s_cbranch_execz L_p2_nocnt
    buffer_store_dword v2, v3, s[16:19], s33 offen sc0 sc1
L_p2_nocnt:
    s_mov_b64 exec, -1
    s_branch L_g1_entry
L_p2_end:
    s_endpgm
L_p2_spec:
    s_lshl_b32 s47, s30, 12
    v_lshl_add_u32 v228, v1, 4, s47
    ds_read_b128 v[20:23], v228 offset:32768
    ds_read_b128 v[24:27], v228 offset:33792
    ds_read_b128 v[28:31], v228 offset:34816
    ds_read_b128 v[32:35], v228 offset:35840
    s_lshl_b32 s47, s30, 13
    v_and_b32 v229, 31, v1
    v_lshrrev_b32 v230, 5, v1
    v_lshlrev_b32 v231, 2, v229
    v_lshl_add_u32 v231, v230, 10, v231
    v_add_u32 v231, s47, v231
    ds_write_b32 v231, v196 offset:0
    ds_write_b32 v231, v212 offset:128
    ds_write_b32 v231, v197 offset:256
    ds_write_b32 v231, v213 offset:384
    ds_write_b32 v231, v198 offset:512
    ds_write_b32 v231, v214 offset:640
    ds_write_b32 v231, v199 offset:768
    ds_write_b32 v231, v215 offset:896
    ds_write_b32 v231, v200 offset:2048
    ds_write_b32 v231, v216 offset:2176
    ds_write_b32 v231, v201 offset:2304
    ds_write_b32 v231, v217 offset:2432
    ds_write_b32 v231, v202 offset:2560
    ds_write_b32 v231, v218 offset:2688
    ds_write_b32 v231, v203 offset:2816
    ds_write_b32 v231, v219 offset:2944
    ds_write_b32 v231, v204 offset:4096
    ds_write_b32 v231, v220 offset:4224
    ds_write_b32 v231, v205 offset:4352
    ds_write_b32 v231, v221 offset:4480
    ds_write_b32 v231, v206 offset:4608
    ds_write_b32 v231, v222 offset:4736
    ds_write_b32 v231, v207 offset:4864
    ds_write_b32 v231, v223 offset:4992
    ds_write_b32 v231, v208 offset:6144
    ds_write_b32 v231, v224 offset:6272
    ds_write_b32 v231, v209 offset:6400
    ds_write_b32 v231, v225 offset:6528
    ds_write_b32 v231, v210 offset:6656
    ds_write_b32 v231, v226 offset:6784
    ds_write_b32 v231, v211 offset:6912
    ds_write_b32 v231, v227 offset:7040
    v_add_u32 v232, s30, v229
    v_sub_u32 v233, 32, v232
    v_lshlrev_b32 v233, 2, v233
    v_cmp_eq_u32 vcc, 0, v232
    v_mov_b32 v234, 256
    s_nop 0
    v_cndmask_b32 v233, v233, v234, vcc
    v_lshlrev_b32 v234, 10, v230
    v_sub_u32 v233, v233, v234
    v_add_u32 v233, 1024, v233
    v_add_u32 v233, s47, v233
    v_add_u32 v234, 6912, v233
    v_or_b32 v235, v232, v230
    v_cmp_eq_u32 vcc, 0, v235
    v_mov_b32 v235, s47
    s_nop 0
    v_cndmask_b32 v234, v234, v235, vcc
    s_waitcnt lgkmcnt(0)
    v_lshlrev_b32 v132, 16, v20
    v_and_b32 v133, s35, v20
    v_lshlrev_b32 v134, 16, v21
    v_and_b32 v135, s35, v21
    v_lshlrev_b32 v136, 16, v22
    v_and_b32 v137, s35, v22
    v_lshlrev_b32 v138, 16, v23
    v_and_b32 v139, s35, v23
    v_lshlrev_b32 v140, 16, v24
    v_and_b32 v141, s35, v24
    v_lshlrev_b32 v142, 16, v25
    v_and_b32 v143, s35, v25
    v_lshlrev_b32 v144, 16, v26
    v_and_b32 v145, s35, v26
    v_lshlrev_b32 v146, 16, v27
    v_and_b32 v147, s35, v27
    v_lshlrev_b32 v148, 16, v28
    v_and_b32 v149, s35, v28
    v_lshlrev_b32 v150, 16, v29
    v_and_b32 v151, s35, v29
    v_lshlrev_b32 v152, 16, v30
    v_and_b32 v153, s35, v30
    v_lshlrev_b32 v154, 16, v31
    v_and_b32 v155, s35, v31
    v_lshlrev_b32 v156, 16, v32
    v_and_b32 v157, s35, v32
    v_lshlrev_b32 v158, 16, v33
    v_and_b32 v159, s35, v33
    v_lshlrev_b32 v160, 16, v34
    v_and_b32 v161, s35, v34
    v_lshlrev_b32 v162, 16, v35
    v_and_b32 v163, s35, v35
    ds_read_b32 v20, v234
    ds_read_b32 v21, v234 offset:128
    ds_read_b32 v22, v233 offset:6656
    ds_read_b32 v23, v233 offset:6784
    ds_read_b32 v24, v233 offset:6400
    ds_read_b32 v25, v233 offset:6528
    ds_read_b32 v26, v233 offset:6144
    ds_read_b32 v27, v233 offset:6272
    ds_read_b32 v28, v233 offset:4864
    ds_read_b32 v29, v233 offset:4992
    ds_read_b32 v30, v233 offset:4608
    ds_read_b32 v31, v233 offset:4736
    ds_read_b32 v32, v233 offset:4352
    ds_read_b32 v33, v233 offset:4480
    ds_read_b32 v34, v233 offset:4096
    ds_read_b32 v35, v233 offset:4224
    s_waitcnt lgkmcnt(0)
    v_pk_mul_f32 v[236:237], v[36:37], v[196:197] op_sel:[0,0] op_sel_hi:[1,0]
    v_pk_fma_f32 v[236:237], v[36:37], v[212:213], v[236:237] op_sel:[1,0,0] op_sel_hi:[0,0,1] neg_lo:[1,0,0]
    v_pk_fma_f32 v[236:237], v[132:133], v[20:21], v[236:237] op_sel:[0,0,0] op_sel_hi:[1,0,1]
    v_pk_fma_f32 v[236:237], v[132:133], v[20:21], v[236:237] op_sel:[1,1,0] op_sel_hi:[0,1,1] neg_hi:[1,0,0]
    v_cvt_pk_bf16_f32 v4, v236, -v237
    v_pk_mul_f32 v[238:239], v[38:39], v[196:197] op_sel:[0,1] op_sel_hi:[1,1]
    v_pk_fma_f32 v[238:239], v[38:39], v[212:213], v[238:239] op_sel:[1,1,0] op_sel_hi:[0,1,1] neg_lo:[1,0,0]
    v_pk_fma_f32 v[238:239], v[134:135], v[22:23], v[238:239] op_sel:[0,0,0] op_sel_hi:[1,0,1]
    v_pk_fma_f32 v[238:239], v[134:135], v[22:23], v[238:239] op_sel:[1,1,0] op_sel_hi:[0,1,1] neg_hi:[1,0,0]
    v_cvt_pk_bf16_f32 v5, v238, -v239
    v_pk_mul_f32 v[240:241], v[40:41], v[198:199] op_sel:[0,0] op_sel_hi:[1,0]
    v_pk_fma_f32 v[240:241], v[40:41], v[214:215], v[240:241] op_sel:[1,0,0] op_sel_hi:[0,0,1] neg_lo:[1,0,0]
    v_pk_fma_f32 v[240:241], v[136:137], v[24:25], v[240:241] op_sel:[0,0,0] op_sel_hi:[1,0,1]
    v_pk_fma_f32 v[240:241], v[136:137], v[24:25], v[240:241] op_sel:[1,1,0] op_sel_hi:[0,1,1] neg_hi:[1,0,0]
    v_cvt_pk_bf16_f32 v6, v240, -v241
    v_pk_mul_f32 v[242:243], v[42:43], v[198:199] op_sel:[0,1] op_sel_hi:[1,1]
    v_pk_fma_f32 v[242:243], v[42:43], v[214:215], v[242:243] op_sel:[1,1,0] op_sel_hi:[0,1,1] neg_lo:[1,0,0]
    v_pk_fma_f32 v[242:243], v[138:139], v[26:27], v[242:243] op_sel:[0,0,0] op_sel_hi:[1,0,1]
    v_pk_fma_f32 v[242:243], v[138:139], v[26:27], v[242:243] op_sel:[1,1,0] op_sel_hi:[0,1,1] neg_hi:[1,0,0]
    v_cvt_pk_bf16_f32 v7, v242, -v243
    v_pk_mul_f32 v[236:237], v[44:45], v[200:201] op_sel:[0,0] op_sel_hi:[1,0]
    v_pk_fma_f32 v[236:237], v[44:45], v[216:217], v[236:237] op_sel:[1,0,0] op_sel_hi:[0,0,1] neg_lo:[1,0,0]
    v_pk_fma_f32 v[236:237], v[140:141], v[28:29], v[236:237] op_sel:[0,0,0] op_sel_hi:[1,0,1]
    v_pk_fma_f32 v[236:237], v[140:141], v[28:29], v[236:237] op_sel:[1,1,0] op_sel_hi:[0,1,1] neg_hi:[1,0,0]
    v_cvt_pk_bf16_f32 v8, v236, -v237
    v_pk_mul_f32 v[238:239], v[46:47], v[200:201] op_sel:[0,1] op_sel_hi:[1,1]
    v_pk_fma_f32 v[238:239], v[46:47], v[216:217], v[238:239] op_sel:[1,1,0] op_sel_hi:[0,1,1] neg_lo:[1,0,0]
    v_pk_fma_f32 v[238:239], v[142:143], v[30:31], v[238:239] op_sel:[0,0,0] op_sel_hi:[1,0,1]
    v_pk_fma_f32 v[238:239], v[142:143], v[30:31], v[238:239] op_sel:[1,1,0] op_sel_hi:[0,1,1] neg_hi:[1,0,0]
    v_cvt_pk_bf16_f32 v9, v238, -v239
    v_pk_mul_f32 v[240:241], v[48:49], v[202:203] op_sel:[0,0] op_sel_hi:[1,0]
    v_pk_fma_f32 v[240:241], v[48:49], v[218:219], v[240:241] op_sel:[1,0,0] op_sel_hi:[0,0,1] neg_lo:[1,0,0]
    v_pk_fma_f32 v[240:241], v[144:145], v[32:33], v[240:241] op_sel:[0,0,0] op_sel_hi:[1,0,1]
    v_pk_fma_f32 v[240:241], v[144:145], v[32:33], v[240:241] op_sel:[1,1,0] op_sel_hi:[0,1,1] neg_hi:[1,0,0]
    v_cvt_pk_bf16_f32 v10, v240, -v241
    v_pk_mul_f32 v[242:243], v[50:51], v[202:203] op_sel:[0,1] op_sel_hi:[1,1]
    v_pk_fma_f32 v[242:243], v[50:51], v[218:219], v[242:243] op_sel:[1,1,0] op_sel_hi:[0,1,1] neg_lo:[1,0,0]
    v_pk_fma_f32 v[242:243], v[146:147], v[34:35], v[242:243] op_sel:[0,0,0] op_sel_hi:[1,0,1]
    v_pk_fma_f32 v[242:243], v[146:147], v[34:35], v[242:243] op_sel:[1,1,0] op_sel_hi:[0,1,1] neg_hi:[1,0,0]
    v_cvt_pk_bf16_f32 v11, v242, -v243
    ds_read_b32 v20, v233 offset:2816
    ds_read_b32 v21, v233 offset:2944
    ds_read_b32 v22, v233 offset:2560
    ds_read_b32 v23, v233 offset:2688
    ds_read_b32 v24, v233 offset:2304
    ds_read_b32 v25, v233 offset:2432
    ds_read_b32 v26, v233 offset:2048
    ds_read_b32 v27, v233 offset:2176
    ds_read_b32 v28, v233 offset:768
    ds_read_b32 v29, v233 offset:896
    ds_read_b32 v30, v233 offset:512
    ds_read_b32 v31, v233 offset:640
    ds_read_b32 v32, v233 offset:256
    ds_read_b32 v33, v233 offset:384
    ds_read_b32 v34, v233 offset:0
    ds_read_b32 v35, v233 offset:128
    s_waitcnt lgkmcnt(0)
    v_pk_mul_f32 v[236:237], v[52:53], v[204:205] op_sel:[0,0] op_sel_hi:[1,0]
    v_pk_fma_f32 v[236:237], v[52:53], v[220:221], v[236:237] op_sel:[1,0,0] op_sel_hi:[0,0,1] neg_lo:[1,0,0]
    v_pk_fma_f32 v[236:237], v[148:149], v[20:21], v[236:237] op_sel:[0,0,0] op_sel_hi:[1,0,1]
    v_pk_fma_f32 v[236:237], v[148:149], v[20:21], v[236:237] op_sel:[1,1,0] op_sel_hi:[0,1,1] neg_hi:[1,0,0]
    v_cvt_pk_bf16_f32 v12, v236, -v237
    v_pk_mul_f32 v[238:239], v[54:55], v[204:205] op_sel:[0,1] op_sel_hi:[1,1]
    v_pk_fma_f32 v[238:239], v[54:55], v[220:221], v[238:239] op_sel:[1,1,0] op_sel_hi:[0,1,1] neg_lo:[1,0,0]
    v_pk_fma_f32 v[238:239], v[150:151], v[22:23], v[238:239] op_sel:[0,0,0] op_sel_hi:[1,0,1]
    v_pk_fma_f32 v[238:239], v[150:151], v[22:23], v[238:239] op_sel:[1,1,0] op_sel_hi:[0,1,1] neg_hi:[1,0,0]
    v_cvt_pk_bf16_f32 v13, v238, -v239
    v_pk_mul_f32 v[240:241], v[56:57], v[206:207] op_sel:[0,0] op_sel_hi:[1,0]
    v_pk_fma_f32 v[240:241], v[56:57], v[222:223], v[240:241] op_sel:[1,0,0] op_sel_hi:[0,0,1] neg_lo:[1,0,0]
    v_pk_fma_f32 v[240:241], v[152:153], v[24:25], v[240:241] op_sel:[0,0,0] op_sel_hi:[1,0,1]
    v_pk_fma_f32 v[240:241], v[152:153], v[24:25], v[240:241] op_sel:[1,1,0] op_sel_hi:[0,1,1] neg_hi:[1,0,0]
    v_cvt_pk_bf16_f32 v14, v240, -v241
    v_pk_mul_f32 v[242:243], v[58:59], v[206:207] op_sel:[0,1] op_sel_hi:[1,1]
    v_pk_fma_f32 v[242:243], v[58:59], v[222:223], v[242:243] op_sel:[1,1,0] op_sel_hi:[0,1,1] neg_lo:[1,0,0]
    v_pk_fma_f32 v[242:243], v[154:155], v[26:27], v[242:243] op_sel:[0,0,0] op_sel_hi:[1,0,1]
    v_pk_fma_f32 v[242:243], v[154:155], v[26:27], v[242:243] op_sel:[1,1,0] op_sel_hi:[0,1,1] neg_hi:[1,0,0]
    v_cvt_pk_bf16_f32 v15, v242, -v243
    v_pk_mul_f32 v[236:237], v[60:61], v[208:209] op_sel:[0,0] op_sel_hi:[1,0]
    v_pk_fma_f32 v[236:237], v[60:61], v[224:225], v[236:237] op_sel:[1,0,0] op_sel_hi:[0,0,1] neg_lo:[1,0,0]
    v_pk_fma_f32 v[236:237], v[156:157], v[28:29], v[236:237] op_sel:[0,0,0] op_sel_hi:[1,0,1]
    v_pk_fma_f32 v[236:237], v[156:157], v[28:29], v[236:237] op_sel:[1,1,0] op_sel_hi:[0,1,1] neg_hi:[1,0,0]
    v_cvt_pk_bf16_f32 v16, v236, -v237
    v_pk_mul_f32 v[238:239], v[62:63], v[208:209] op_sel:[0,1] op_sel_hi:[1,1]
    v_pk_fma_f32 v[238:239], v[62:63], v[224:225], v[238:239] op_sel:[1,1,0] op_sel_hi:[0,1,1] neg_lo:[1,0,0]
    v_pk_fma_f32 v[238:239], v[158:159], v[30:31], v[238:239] op_sel:[0,0,0] op_sel_hi:[1,0,1]
    v_pk_fma_f32 v[238:239], v[158:159], v[30:31], v[238:239] op_sel:[1,1,0] op_sel_hi:[0,1,1] neg_hi:[1,0,0]
    v_cvt_pk_bf16_f32 v17, v238, -v239
    v_pk_mul_f32 v[240:241], v[64:65], v[210:211] op_sel:[0,0] op_sel_hi:[1,0]
    v_pk_fma_f32 v[240:241], v[64:65], v[226:227], v[240:241] op_sel:[1,0,0] op_sel_hi:[0,0,1] neg_lo:[1,0,0]
    v_pk_fma_f32 v[240:241], v[160:161], v[32:33], v[240:241] op_sel:[0,0,0] op_sel_hi:[1,0,1]
    v_pk_fma_f32 v[240:241], v[160:161], v[32:33], v[240:241] op_sel:[1,1,0] op_sel_hi:[0,1,1] neg_hi:[1,0,0]
    v_cvt_pk_bf16_f32 v18, v240, -v241
    v_pk_mul_f32 v[242:243], v[66:67], v[210:211] op_sel:[0,1] op_sel_hi:[1,1]
    v_pk_fma_f32 v[242:243], v[66:67], v[226:227], v[242:243] op_sel:[1,1,0] op_sel_hi:[0,1,1] neg_lo:[1,0,0]
    v_pk_fma_f32 v[242:243], v[162:163], v[34:35], v[242:243] op_sel:[0,0,0] op_sel_hi:[1,0,1]
    v_pk_fma_f32 v[242:243], v[162:163], v[34:35], v[242:243] op_sel:[1,1,0] op_sel_hi:[0,1,1] neg_hi:[1,0,0]
    v_cvt_pk_bf16_f32 v19, v242, -v243
    s_branch L_p2_specd
L_g1_entry:
    s_load_dwordx4 s[4:7], s[0:1], 32
    s_load_dwordx2 s[24:25], s[0:1], 48
    s_load_dwordx2 s[26:27], s[0:1], 80
    v_and_b32 v1, 63, v0
    v_lshrrev_b32 v2, 6, v0
    s_nop 0
    v_readfirstlane_b32 s28, v2
    s_and_b32 s30, s2, 1
    s_lshl_b32 s30, s30, 2
    s_bfe_u32 s52, s2, 0x20003
    s_add_u32 s30, s30, s52
    s_bfe_u32 s29, s2, 0x20001
    s_mul_i32 s29, s29, 7
    s_lshr_b32 s53, s2, 5
    s_add_u32 s29, s29, s53
    s_mov_b32 s63, 0
    s_and_b32 s55, s2, 1
    s_mul_i32 s55, s55, 16
    s_lshl_b32 s31, s29, 8
    s_lshl_b32 s32, s30, 8
    s_waitcnt lgkmcnt(0)
    s_mov_b32 s8, s4
    s_mov_b32 s9, s5
    s_mov_b32 s10, 0xe00000
    s_mov_b32 s11, 0x20000
    s_add_u32 s12, s26, 0x1200000
    s_addc_u32 s13, s27, 0
    s_mov_b32 s14, 0x400000
    s_mov_b32 s15, 0x20000
    s_add_u32 s16, s26, 0x1600000
    s_addc_u32 s17, s27, 0
    s_mov_b32 s18, 0x700000
    s_mov_b32 s19, 0x20000
    s_mov_b32 s20, s6
    s_mov_b32 s21, s7
    s_mov_b32 s22, 0x1c00
    s_mov_b32 s23, 0x20000
    s_cmp_lt_u32 s2, 224
    s_cbranch_scc1 L_g1_main
    s_cmp_ge_u32 s28, 4
    s_cbranch_scc0 L_g1_nb23
    s_barrier
    s_barrier
    s_barrier
    s_barrier
    s_barrier
    s_barrier
L_g1_nb23:
    s_add_u32 s44, s26, 0x1e00000
    s_addc_u32 s45, s27, 0
    s_mov_b32 s46, 0x400000
    s_mov_b32 s47, 0x20000
    s_sub_u32 s33, s2, 224
    s_lshl_b32 s33, s33, 17
    v_lshlrev_b32 v2, 4, v0
    v_mov_b32 v4, -1
    v_mov_b32 v5, -1
    v_mov_b32 v6, -1
    v_mov_b32 v7, -1
    s_mov_b32 s34, 0
L_g1_clr:
    buffer_store_dwordx4 v[4:7], v2, s[44:47], s33 offen sc0 sc1
    s_add_u32 s33, s33, 8192
    s_add_u32 s34, s34, 1
    s_cmp_lt_u32 s34, 16
    s_cbranch_scc1 L_g1_clr
    s_waitcnt vmcnt(0)
    s_barrier
    s_add_u32 s36, s26, 0x2820000
    s_addc_u32 s37, s27, 0
    s_mov_b32 s38, 0x9000
    s_mov_b32 s39, 0x20000
    s_add_u32 s33, s2, 32
    s_lshl_b32 s33, s33, 7
    v_mov_b32 v2, 1
    v_mov_b32 v3, 0
    v_cmp_eq_u32 vcc, 0, v0
    s_nop 0
    s_and_saveexec_b64 s[34:35], vcc
    s_cbranch_execz L_g1_nofl
    buffer_store_dword v2, v3, s[36:39], s33 offen sc0 sc1
L_g1_nofl:
    s_mov_b64 exec, -1
    s_mov_b32 s48, s24
    s_mov_b32 s49, s25
    s_mov_b32 s50, 0xe00000
    s_mov_b32 s51, 0x20000
    s_sub_u32 s33, s2, 224
    s_and_b32 s34, s33, 15
    s_lshr_b32 s35, s33, 4
    s_mul_i32 s35, s35, 7340032
    s_lshl_b32 s33, s34, 16
    s_add_u32 s33, s33, s35
    s_cmp_ge_u32 s28, 4
    s_cbranch_scc1 L_g1_now2
    v_lshlrev_b32 v2, 7, v1
    s_mul_i32 s34, s28, 16384
    s_add_u32 s33, s33, s34
    s_mov_b32 s35, 0
L_g1_w2l:
    s_add_u32 s34, s33, 0
    buffer_load_dword v9, v2, s[48:51], s34 offen
    s_waitcnt vmcnt(0)
    s_add_u32 s34, s33, 8192
    buffer_load_dword v9, v2, s[48:51], s34 offen
    s_waitcnt vmcnt(0)
    s_add_u32 s33, s33, 1048576
    s_add_u32 s35, s35, 1
    s_cmp_lt_u32 s35, 7
    s_cbranch_scc1 L_g1_w2l
L_g1_now2:
    s_waitcnt vmcnt(0)
    s_mov_b32 s3, -1
    s_branch L_g2start
L_g1_main:
    s_cmp_ge_u32 s28, 4
    s_cbranch_scc1 L_g1_prod
L_g1_cons:
    s_and_b32 s33, s28, 1
    s_lshr_b32 s36, s28, 1
    v_lshrrev_b32 v2, 4, v1
    v_bfe_u32 v3, v1, 2, 2
    v_and_b32 v4, 3, v1
    v_lshl_add_u32 v5, v2, 2, v3
    v_and_b32 v6, 7, v5
    v_lshlrev_b32 v6, 1, v6
    v_lshrrev_b32 v7, 1, v4
    v_and_b32 v9, 1, v4
    s_lshl_b32 s35, s33, 3
    v_add_u32 v10, s35, v7
    v_xor_b32 v10, v10, v6
    v_lshlrev_b32 v10, 4, v10
    v_lshl_add_u32 v10, v9, 3, v10
    v_lshl_add_u32 v10, v5, 8, v10
    v_mov_b32 v208, v10
    v_xor_b32 v209, 32, v10
    v_xor_b32 v210, 64, v10
    v_xor_b32 v211, 96, v10
    s_lshl_b32 s35, s36, 3
    v_add_u32 v10, s35, v7
    v_xor_b32 v10, v10, v6
    v_lshlrev_b32 v10, 4, v10
    v_lshl_add_u32 v10, v9, 3, v10
    v_lshl_add_u32 v10, v5, 8, v10
    v_add_u32 v10, 16384, v10
    v_mov_b32 v212, v10
    v_xor_b32 v213, 32, v10
    v_xor_b32 v214, 64, v10
    v_xor_b32 v215, 96, v10
    v_mov_b32 v200, v208
    v_mov_b32 v204, v212
    v_mov_b32 v201, v209
    v_mov_b32 v205, v213
    v_mov_b32 v202, v210
    v_mov_b32 v206, v214
    v_mov_b32 v203, v211
    v_mov_b32 v207, v215
    v_and_b32 v2, 15, v1
    v_lshlrev_b32 v2, 1, v2
    s_lshl_b32 s37, s36, 7
    s_add_u32 s37, s37, s31
    buffer_load_ushort v216, v2, s[20:23], s37 offen offset:0
    buffer_load_ushort v217, v2, s[20:23], s37 offen offset:32
    buffer_load_ushort v218, v2, s[20:23], s37 offen offset:64
    buffer_load_ushort v219, v2, s[20:23], s37 offen offset:96
    v_and_b32 v2, 15, v1
    v_lshlrev_b32 v2, 11, v2
    v_lshrrev_b32 v3, 4, v1
    v_lshl_add_u32 v220, v3, 4, v2
    s_lshl_b32 s38, s29, 7
    s_lshl_b32 s39, s36, 6
    s_add_u32 s38, s38, s39
    s_lshl_b32 s38, s38, 11
    s_add_u32 s38, s38, s32
    s_lshl_b32 s39, s33, 7
    s_add_u32 s38, s38, s39
    v_mov_b32 v8, 0
    v_mov_b32 v9, 0
    v_mov_b32 v10, 0
    v_mov_b32 v11, 0
    v_mov_b32 v12, 0
    v_mov_b32 v13, 0
    v_mov_b32 v14, 0
    v_mov_b32 v15, 0
    v_mov_b32 v16, 0
    v_mov_b32 v17, 0
    v_mov_b32 v18, 0
    v_mov_b32 v19, 0
    v_mov_b32 v20, 0
    v_mov_b32 v21, 0
    v_mov_b32 v22, 0
    v_mov_b32 v23, 0
    v_mov_b32 v24, 0
    v_mov_b32 v25, 0
    v_mov_b32 v26, 0
    v_mov_b32 v27, 0
    v_mov_b32 v28, 0
    v_mov_b32 v29, 0
    v_mov_b32 v30, 0
    v_mov_b32 v31, 0
    v_mov_b32 v32, 0
    v_mov_b32 v33, 0
    v_mov_b32 v34, 0
    v_mov_b32 v35, 0
    v_mov_b32 v36, 0
    v_mov_b32 v37, 0
    v_mov_b32 v38, 0
    v_mov_b32 v39, 0
    v_mov_b32 v40, 0
    v_mov_b32 v41, 0
    v_mov_b32 v42, 0
    v_mov_b32 v43, 0
    v_mov_b32 v44, 0
    v_mov_b32 v45, 0
    v_mov_b32 v46, 0
    v_mov_b32 v47, 0
    v_mov_b32 v48, 0
    v_mov_b32 v49, 0
    v_mov_b32 v50, 0
    v_mov_b32 v51, 0
    v_mov_b32 v52, 0
    v_mov_b32 v53, 0
    v_mov_b32 v54, 0
    v_mov_b32 v55, 0
    v_mov_b32 v56, 0
    v_mov_b32 v57, 0
    v_mov_b32 v58, 0
    v_mov_b32 v59, 0
    v_mov_b32 v60, 0
    v_mov_b32 v61, 0
    v_mov_b32 v62, 0
    v_mov_b32 v63, 0
    v_mov_b32 v64, 0
    v_mov_b32 v65, 0
    v_mov_b32 v66, 0
    v_mov_b32 v67, 0
    v_mov_b32 v68, 0
    v_mov_b32 v69, 0
    v_mov_b32 v70, 0
    v_mov_b32 v71, 0
    s_mov_b32 s34, 0
    s_mov_b32 s35, 0
    s_barrier
    s_barrier
    v_add_u32 v200, 65536, v208
    v_add_u32 v204, 65536, v212
    v_add_u32 v201, 65536, v209
    v_add_u32 v205, 65536, v213
    v_add_u32 v202, 65536, v210
    v_add_u32 v206, 65536, v214
    v_add_u32 v203, 65536, v211
    v_add_u32 v207, 65536, v215
    ds_read_b64_tr_b16 v[72:73], v208 offset:0
    ds_read_b64_tr_b16 v[74:75], v208 offset:4096
    ds_read_b64_tr_b16 v[88:89], v212 offset:0
    ds_read_b64_tr_b16 v[90:91], v212 offset:4096
    ds_read_b64_tr_b16 v[76:77], v209 offset:0
    ds_read_b64_tr_b16 v[78:79], v209 offset:4096
    ds_read_b64_tr_b16 v[92:93], v213 offset:0
    ds_read_b64_tr_b16 v[94:95], v213 offset:4096
    ds_read_b64_tr_b16 v[80:81], v210 offset:0
    ds_read_b64_tr_b16 v[82:83], v210 offset:4096
    ds_read_b64_tr_b16 v[96:97], v214 offset:0
    ds_read_b64_tr_b16 v[98:99], v214 offset:4096
    ds_read_b64_tr_b16 v[84:85], v211 offset:0
    ds_read_b64_tr_b16 v[86:87], v211 offset:4096
    ds_read_b64_tr_b16 v[100:101], v215 offset:0
    ds_read_b64_tr_b16 v[102:103], v215 offset:4096
    ds_read_b64_tr_b16 v[104:105], v208 offset:8192
    ds_read_b64_tr_b16 v[106:107], v208 offset:12288
    ds_read_b64_tr_b16 v[120:121], v212 offset:8192
    ds_read_b64_tr_b16 v[122:123], v212 offset:12288
    ds_read_b64_tr_b16 v[108:109], v209 offset:8192
    ds_read_b64_tr_b16 v[110:111], v209 offset:12288
    ds_read_b64_tr_b16 v[124:125], v213 offset:8192
    ds_read_b64_tr_b16 v[126:127], v213 offset:12288
    ds_read_b64_tr_b16 v[112:113], v210 offset:8192
    ds_read_b64_tr_b16 v[114:115], v210 offset:12288
    ds_read_b64_tr_b16 v[128:129], v214 offset:8192
    ds_read_b64_tr_b16 v[130:131], v214 offset:12288
    ds_read_b64_tr_b16 v[116:117], v211 offset:8192
    ds_read_b64_tr_b16 v[118:119], v211 offset:12288
    ds_read_b64_tr_b16 v[132:133], v215 offset:8192
    ds_read_b64_tr_b16 v[134:135], v215 offset:12288
L_g1_cloop:
    s_waitcnt lgkmcnt(0)
    s_barrier
    v_mfma_f32_16x16x32_bf16 v[8:11], v[72:75], v[88:91], v[8:11]
    ds_read_b64_tr_b16 v[136:137], v208 offset:32768
    ds_read_b64_tr_b16 v[138:139], v208 offset:36864
    v_mfma_f32_16x16x32_bf16 v[24:27], v[72:75], v[92:95], v[24:27]
    ds_read_b64_tr_b16 v[152:153], v212 offset:32768
    v_mfma_f32_16x16x32_bf16 v[12:15], v[76:79], v[88:91], v[12:15]
    ds_read_b64_tr_b16 v[154:155], v212 offset:36864
    ds_read_b64_tr_b16 v[140:141], v209 offset:32768
    v_mfma_f32_16x16x32_bf16 v[28:31], v[76:79], v[92:95], v[28:31]
    ds_read_b64_tr_b16 v[142:143], v209 offset:36864
    v_mfma_f32_16x16x32_bf16 v[40:43], v[72:75], v[96:99], v[40:43]
    ds_read_b64_tr_b16 v[156:157], v213 offset:32768
    ds_read_b64_tr_b16 v[158:159], v213 offset:36864
    v_mfma_f32_16x16x32_bf16 v[44:47], v[76:79], v[96:99], v[44:47]
    ds_read_b64_tr_b16 v[144:145], v210 offset:32768
    v_mfma_f32_16x16x32_bf16 v[16:19], v[80:83], v[88:91], v[16:19]
    ds_read_b64_tr_b16 v[146:147], v210 offset:36864
    ds_read_b64_tr_b16 v[160:161], v214 offset:32768
    v_mfma_f32_16x16x32_bf16 v[32:35], v[80:83], v[92:95], v[32:35]
    ds_read_b64_tr_b16 v[162:163], v214 offset:36864
    v_mfma_f32_16x16x32_bf16 v[48:51], v[80:83], v[96:99], v[48:51]
    ds_read_b64_tr_b16 v[148:149], v211 offset:32768
    ds_read_b64_tr_b16 v[150:151], v211 offset:36864
    v_mfma_f32_16x16x32_bf16 v[56:59], v[72:75], v[100:103], v[56:59]
    ds_read_b64_tr_b16 v[164:165], v215 offset:32768
    v_mfma_f32_16x16x32_bf16 v[60:63], v[76:79], v[100:103], v[60:63]
    ds_read_b64_tr_b16 v[166:167], v215 offset:36864
    ds_read_b64_tr_b16 v[168:169], v208 offset:40960
    v_mfma_f32_16x16x32_bf16 v[64:67], v[80:83], v[100:103], v[64:67]
    ds_read_b64_tr_b16 v[170:171], v208 offset:45056
    v_mfma_f32_16x16x32_bf16 v[20:23], v[84:87], v[88:91], v[20:23]
    ds_read_b64_tr_b16 v[184:185], v212 offset:40960
    ds_read_b64_tr_b16 v[186:187], v212 offset:45056
    v_mfma_f32_16x16x32_bf16 v[36:39], v[84:87], v[92:95], v[36:39]
    ds_read_b64_tr_b16 v[172:173], v209 offset:40960
    v_mfma_f32_16x16x32_bf16 v[52:55], v[84:87], v[96:99], v[52:55]
    ds_read_b64_tr_b16 v[174:175], v209 offset:45056
    ds_read_b64_tr_b16 v[188:189], v213 offset:40960
    v_mfma_f32_16x16x32_bf16 v[68:71], v[84:87], v[100:103], v[68:71]
    ds_read_b64_tr_b16 v[190:191], v213 offset:45056
    v_mfma_f32_16x16x32_bf16 v[8:11], v[104:107], v[120:123], v[8:11]
    ds_read_b64_tr_b16 v[176:177], v210 offset:40960
    ds_read_b64_tr_b16 v[178:179], v210 offset:45056
    v_mfma_f32_16x16x32_bf16 v[24:27], v[104:107], v[124:127], v[24:27]
    ds_read_b64_tr_b16 v[192:193], v214 offset:40960
    v_mfma_f32_16x16x32_bf16 v[12:15], v[108:111], v[120:123], v[12:15]
    ds_read_b64_tr_b16 v[194:195], v214 offset:45056
    ds_read_b64_tr_b16 v[180:181], v211 offset:40960
    v_mfma_f32_16x16x32_bf16 v[28:31], v[108:111], v[124:127], v[28:31]
    ds_read_b64_tr_b16 v[182:183], v211 offset:45056
    v_mfma_f32_16x16x32_bf16 v[40:43], v[104:107], v[128:131], v[40:43]
    ds_read_b64_tr_b16 v[196:197], v215 offset:40960
    ds_read_b64_tr_b16 v[198:199], v215 offset:45056
    v_mfma_f32_16x16x32_bf16 v[44:47], v[108:111], v[128:131], v[44:47]
    v_mfma_f32_16x16x32_bf16 v[16:19], v[112:115], v[120:123], v[16:19]
    v_mfma_f32_16x16x32_bf16 v[32:35], v[112:115], v[124:127], v[32:35]
    v_mfma_f32_16x16x32_bf16 v[48:51], v[112:115], v[128:131], v[48:51]
    v_mfma_f32_16x16x32_bf16 v[56:59], v[104:107], v[132:135], v[56:59]
    v_mfma_f32_16x16x32_bf16 v[60:63], v[108:111], v[132:135], v[60:63]
    v_mfma_f32_16x16x32_bf16 v[64:67], v[112:115], v[132:135], v[64:67]
    v_mfma_f32_16x16x32_bf16 v[20:23], v[116:119], v[120:123], v[20:23]
    v_mfma_f32_16x16x32_bf16 v[36:39], v[116:119], v[124:127], v[36:39]
    v_mfma_f32_16x16x32_bf16 v[52:55], v[116:119], v[128:131], v[52:55]
    v_mfma_f32_16x16x32_bf16 v[68:71], v[116:119], v[132:135], v[68:71]
    s_waitcnt lgkmcnt(0)
    s_barrier
    v_mfma_f32_16x16x32_bf16 v[8:11], v[136:139], v[152:155], v[8:11]
    ds_read_b64_tr_b16 v[72:73], v200 offset:0
    ds_read_b64_tr_b16 v[74:75], v200 offset:4096
    v_mfma_f32_16x16x32_bf16 v[24:27], v[136:139], v[156:159], v[24:27]
    ds_read_b64_tr_b16 v[88:89], v204 offset:0
    v_mfma_f32_16x16x32_bf16 v[12:15], v[140:143], v[152:155], v[12:15]
    ds_read_b64_tr_b16 v[90:91], v204 offset:4096
    ds_read_b64_tr_b16 v[76:77], v201 offset:0
    v_mfma_f32_16x16x32_bf16 v[28:31], v[140:143], v[156:159], v[28:31]
    ds_read_b64_tr_b16 v[78:79], v201 offset:4096
    v_mfma_f32_16x16x32_bf16 v[40:43], v[136:139], v[160:163], v[40:43]
    ds_read_b64_tr_b16 v[92:93], v205 offset:0
    ds_read_b64_tr_b16 v[94:95], v205 offset:4096
    v_mfma_f32_16x16x32_bf16 v[44:47], v[140:143], v[160:163], v[44:47]
    ds_read_b64_tr_b16 v[80:81], v202 offset:0
    v_mfma_f32_16x16x32_bf16 v[16:19], v[144:147], v[152:155], v[16:19]
    ds_read_b64_tr_b16 v[82:83], v202 offset:4096
    ds_read_b64_tr_b16 v[96:97], v206 offset:0
    v_mfma_f32_16x16x32_bf16 v[32:35], v[144:147], v[156:159], v[32:35]
    ds_read_b64_tr_b16 v[98:99], v206 offset:4096
    v_mfma_f32_16x16x32_bf16 v[48:51], v[144:147], v[160:163], v[48:51]
    ds_read_b64_tr_b16 v[84:85], v203 offset:0
    ds_read_b64_tr_b16 v[86:87], v203 offset:4096
    v_mfma_f32_16x16x32_bf16 v[56:59], v[136:139], v[164:167], v[56:59]
    ds_read_b64_tr_b16 v[100:101], v207 offset:0
    v_mfma_f32_16x16x32_bf16 v[60:63], v[140:143], v[164:167], v[60:63]
    ds_read_b64_tr_b16 v[102:103], v207 offset:4096
    ds_read_b64_tr_b16 v[104:105], v200 offset:8192
    v_mfma_f32_16x16x32_bf16 v[64:67], v[144:147], v[164:167], v[64:67]
    ds_read_b64_tr_b16 v[106:107], v200 offset:12288
    v_mfma_f32_16x16x32_bf16 v[20:23], v[148:151], v[152:155], v[20:23]
    ds_read_b64_tr_b16 v[120:121], v204 offset:8192
    ds_read_b64_tr_b16 v[122:123], v204 offset:12288
    v_mfma_f32_16x16x32_bf16 v[36:39], v[148:151], v[156:159], v[36:39]
    ds_read_b64_tr_b16 v[108:109], v201 offset:8192
    v_mfma_f32_16x16x32_bf16 v[52:55], v[148:151], v[160:163], v[52:55]
    ds_read_b64_tr_b16 v[110:111], v201 offset:12288
    ds_read_b64_tr_b16 v[124:125], v205 offset:8192
    v_mfma_f32_16x16x32_bf16 v[68:71], v[148:151], v[164:167], v[68:71]
    ds_read_b64_tr_b16 v[126:127], v205 offset:12288
    v_mfma_f32_16x16x32_bf16 v[8:11], v[168:171], v[184:187], v[8:11]
    ds_read_b64_tr_b16 v[112:113], v202 offset:8192
    ds_read_b64_tr_b16 v[114:115], v202 offset:12288
    v_mfma_f32_16x16x32_bf16 v[24:27], v[168:171], v[188:191], v[24:27]
    ds_read_b64_tr_b16 v[128:129], v206 offset:8192
    v_mfma_f32_16x16x32_bf16 v[12:15], v[172:175], v[184:187], v[12:15]
    ds_read_b64_tr_b16 v[130:131], v206 offset:12288
    ds_read_b64_tr_b16 v[116:117], v203 offset:8192
    v_mfma_f32_16x16x32_bf16 v[28:31], v[172:175], v[188:191], v[28:31]
    ds_read_b64_tr_b16 v[118:119], v203 offset:12288
    v_mfma_f32_16x16x32_bf16 v[40:43], v[168:171], v[192:195], v[40:43]
    ds_read_b64_tr_b16 v[132:133], v207 offset:8192
    ds_read_b64_tr_b16 v[134:135], v207 offset:12288
    v_mfma_f32_16x16x32_bf16 v[44:47], v[172:175], v[192:195], v[44:47]
    v_mfma_f32_16x16x32_bf16 v[16:19], v[176:179], v[184:187], v[16:19]
    v_mfma_f32_16x16x32_bf16 v[32:35], v[176:179], v[188:191], v[32:35]
    v_mfma_f32_16x16x32_bf16 v[48:51], v[176:179], v[192:195], v[48:51]
    v_mfma_f32_16x16x32_bf16 v[56:59], v[168:171], v[196:199], v[56:59]
    v_mfma_f32_16x16x32_bf16 v[60:63], v[172:175], v[196:199], v[60:63]
    v_mfma_f32_16x16x32_bf16 v[64:67], v[176:179], v[196:199], v[64:67]
    v_mfma_f32_16x16x32_bf16 v[20:23], v[180:183], v[184:187], v[20:23]
    v_mfma_f32_16x16x32_bf16 v[36:39], v[180:183], v[188:191], v[36:39]
    v_mfma_f32_16x16x32_bf16 v[52:55], v[180:183], v[192:195], v[52:55]
    v_mfma_f32_16x16x32_bf16 v[68:71], v[180:183], v[196:199], v[68:71]
    s_waitcnt lgkmcnt(0)
    s_barrier
    v_mfma_f32_16x16x32_bf16 v[8:11], v[72:75], v[88:91], v[8:11]
    ds_read_b64_tr_b16 v[136:137], v200 offset:32768
    ds_read_b64_tr_b16 v[138:139], v200 offset:36864
    v_mfma_f32_16x16x32_bf16 v[24:27], v[72:75], v[92:95], v[24:27]
    ds_read_b64_tr_b16 v[152:153], v204 offset:32768
    v_mfma_f32_16x16x32_bf16 v[12:15], v[76:79], v[88:91], v[12:15]
    ds_read_b64_tr_b16 v[154:155], v204 offset:36864
    ds_read_b64_tr_b16 v[140:141], v201 offset:32768
    v_mfma_f32_16x16x32_bf16 v[28:31], v[76:79], v[92:95], v[28:31]
    ds_read_b64_tr_b16 v[142:143], v201 offset:36864
    v_mfma_f32_16x16x32_bf16 v[40:43], v[72:75], v[96:99], v[40:43]
    ds_read_b64_tr_b16 v[156:157], v205 offset:32768
    ds_read_b64_tr_b16 v[158:159], v205 offset:36864
    v_mfma_f32_16x16x32_bf16 v[44:47], v[76:79], v[96:99], v[44:47]
    ds_read_b64_tr_b16 v[144:145], v202 offset:32768
    v_mfma_f32_16x16x32_bf16 v[16:19], v[80:83], v[88:91], v[16:19]
    ds_read_b64_tr_b16 v[146:147], v202 offset:36864
    ds_read_b64_tr_b16 v[160:161], v206 offset:32768
    v_mfma_f32_16x16x32_bf16 v[32:35], v[80:83], v[92:95], v[32:35]
    ds_read_b64_tr_b16 v[162:163], v206 offset:36864
    v_mfma_f32_16x16x32_bf16 v[48:51], v[80:83], v[96:99], v[48:51]
    ds_read_b64_tr_b16 v[148:149], v203 offset:32768
    ds_read_b64_tr_b16 v[150:151], v203 offset:36864
    v_mfma_f32_16x16x32_bf16 v[56:59], v[72:75], v[100:103], v[56:59]
    ds_read_b64_tr_b16 v[164:165], v207 offset:32768
    v_mfma_f32_16x16x32_bf16 v[60:63], v[76:79], v[100:103], v[60:63]
    ds_read_b64_tr_b16 v[166:167], v207 offset:36864
    ds_read_b64_tr_b16 v[168:169], v200 offset:40960
    v_mfma_f32_16x16x32_bf16 v[64:67], v[80:83], v[100:103], v[64:67]
    ds_read_b64_tr_b16 v[170:171], v200 offset:45056
    v_mfma_f32_16x16x32_bf16 v[20:23], v[84:87], v[88:91], v[20:23]
    ds_read_b64_tr_b16 v[184:185], v204 offset:40960
    ds_read_b64_tr_b16 v[186:187], v204 offset:45056
    v_mfma_f32_16x16x32_bf16 v[36:39], v[84:87], v[92:95], v[36:39]
    ds_read_b64_tr_b16 v[172:173], v201 offset:40960
    v_mfma_f32_16x16x32_bf16 v[52:55], v[84:87], v[96:99], v[52:55]
    ds_read_b64_tr_b16 v[174:175], v201 offset:45056
    ds_read_b64_tr_b16 v[188:189], v205 offset:40960
    v_mfma_f32_16x16x32_bf16 v[68:71], v[84:87], v[100:103], v[68:71]
    ds_read_b64_tr_b16 v[190:191], v205 offset:45056
    v_mfma_f32_16x16x32_bf16 v[8:11], v[104:107], v[120:123], v[8:11]
    ds_read_b64_tr_b16 v[176:177], v202 offset:40960
    ds_read_b64_tr_b16 v[178:179], v202 offset:45056
    v_mfma_f32_16x16x32_bf16 v[24:27], v[104:107], v[124:127], v[24:27]
    ds_read_b64_tr_b16 v[192:193], v206 offset:40960
    v_mfma_f32_16x16x32_bf16 v[12:15], v[108:111], v[120:123], v[12:15]
    ds_read_b64_tr_b16 v[194:195], v206 offset:45056
    ds_read_b64_tr_b16 v[180:181], v203 offset:40960
    v_mfma_f32_16x16x32_bf16 v[28:31], v[108:111], v[124:127], v[28:31]
    ds_read_b64_tr_b16 v[182:183], v203 offset:45056
    v_mfma_f32_16x16x32_bf16 v[40:43], v[104:107], v[128:131], v[40:43]
    ds_read_b64_tr_b16 v[196:197], v207 offset:40960
    ds_read_b64_tr_b16 v[198:199], v207 offset:45056
    v_mfma_f32_16x16x32_bf16 v[44:47], v[108:111], v[128:131], v[44:47]
    v_mfma_f32_16x16x32_bf16 v[16:19], v[112:115], v[120:123], v[16:19]
    v_mfma_f32_16x16x32_bf16 v[32:35], v[112:115], v[124:127], v[32:35]
    v_mfma_f32_16x16x32_bf16 v[48:51], v[112:115], v[128:131], v[48:51]
    v_mfma_f32_16x16x32_bf16 v[56:59], v[104:107], v[132:135], v[56:59]
    v_mfma_f32_16x16x32_bf16 v[60:63], v[108:111], v[132:135], v[60:63]
    v_mfma_f32_16x16x32_bf16 v[64:67], v[112:115], v[132:135], v[64:67]
    v_mfma_f32_16x16x32_bf16 v[20:23], v[116:119], v[120:123], v[20:23]
    v_mfma_f32_16x16x32_bf16 v[36:39], v[116:119], v[124:127], v[36:39]
    v_mfma_f32_16x16x32_bf16 v[52:55], v[116:119], v[128:131], v[52:55]
    v_mfma_f32_16x16x32_bf16 v[68:71], v[116:119], v[132:135], v[68:71]
    s_waitcnt lgkmcnt(0)
    s_barrier
    v_mfma_f32_16x16x32_bf16 v[8:11], v[136:139], v[152:155], v[8:11]
    ds_read_b64_tr_b16 v[72:73], v208 offset:0
    ds_read_b64_tr_b16 v[74:75], v208 offset:4096
    v_mfma_f32_16x16x32_bf16 v[24:27], v[136:139], v[156:159], v[24:27]
    ds_read_b64_tr_b16 v[88:89], v212 offset:0
    v_mfma_f32_16x16x32_bf16 v[12:15], v[140:143], v[152:155], v[12:15]
    ds_read_b64_tr_b16 v[90:91], v212 offset:4096
    ds_read_b64_tr_b16 v[76:77], v209 offset:0
    v_mfma_f32_16x16x32_bf16 v[28:31], v[140:143], v[156:159], v[28:31]
    ds_read_b64_tr_b16 v[78:79], v209 offset:4096
    v_mfma_f32_16x16x32_bf16 v[40:43], v[136:139], v[160:163], v[40:43]
    ds_read_b64_tr_b16 v[92:93], v213 offset:0
    ds_read_b64_tr_b16 v[94:95], v213 offset:4096
    v_mfma_f32_16x16x32_bf16 v[44:47], v[140:143], v[160:163], v[44:47]
    ds_read_b64_tr_b16 v[80:81], v210 offset:0
    v_mfma_f32_16x16x32_bf16 v[16:19], v[144:147], v[152:155], v[16:19]
    ds_read_b64_tr_b16 v[82:83], v210 offset:4096
    ds_read_b64_tr_b16 v[96:97], v214 offset:0
    v_mfma_f32_16x16x32_bf16 v[32:35], v[144:147], v[156:159], v[32:35]
    ds_read_b64_tr_b16 v[98:99], v214 offset:4096
    v_mfma_f32_16x16x32_bf16 v[48:51], v[144:147], v[160:163], v[48:51]
    ds_read_b64_tr_b16 v[84:85], v211 offset:0
    ds_read_b64_tr_b16 v[86:87], v211 offset:4096
    v_mfma_f32_16x16x32_bf16 v[56:59], v[136:139], v[164:167], v[56:59]
    ds_read_b64_tr_b16 v[100:101], v215 offset:0
    v_mfma_f32_16x16x32_bf16 v[60:63], v[140:143], v[164:167], v[60:63]
    ds_read_b64_tr_b16 v[102:103], v215 offset:4096
    ds_read_b64_tr_b16 v[104:105], v208 offset:8192
    v_mfma_f32_16x16x32_bf16 v[64:67], v[144:147], v[164:167], v[64:67]
    ds_read_b64_tr_b16 v[106:107], v208 offset:12288
    v_mfma_f32_16x16x32_bf16 v[20:23], v[148:151], v[152:155], v[20:23]
    ds_read_b64_tr_b16 v[120:121], v212 offset:8192
    ds_read_b64_tr_b16 v[122:123], v212 offset:12288
    v_mfma_f32_16x16x32_bf16 v[36:39], v[148:151], v[156:159], v[36:39]
    ds_read_b64_tr_b16 v[108:109], v209 offset:8192
    v_mfma_f32_16x16x32_bf16 v[52:55], v[148:151], v[160:163], v[52:55]
    ds_read_b64_tr_b16 v[110:111], v209 offset:12288
    ds_read_b64_tr_b16 v[124:125], v213 offset:8192
    v_mfma_f32_16x16x32_bf16 v[68:71], v[148:151], v[164:167], v[68:71]
    ds_read_b64_tr_b16 v[126:127], v213 offset:12288
    v_mfma_f32_16x16x32_bf16 v[8:11], v[168:171], v[184:187], v[8:11]
    ds_read_b64_tr_b16 v[112:113], v210 offset:8192
    ds_read_b64_tr_b16 v[114:115], v210 offset:12288
    v_mfma_f32_16x16x32_bf16 v[24:27], v[168:171], v[188:191], v[24:27]
    ds_read_b64_tr_b16 v[128:129], v214 offset:8192
    v_mfma_f32_16x16x32_bf16 v[12:15], v[172:175], v[184:187], v[12:15]
    ds_read_b64_tr_b16 v[130:131], v214 offset:12288
    ds_read_b64_tr_b16 v[116:117], v211 offset:8192
    v_mfma_f32_16x16x32_bf16 v[28:31], v[172:175], v[188:191], v[28:31]
    ds_read_b64_tr_b16 v[118:119], v211 offset:12288
    v_mfma_f32_16x16x32_bf16 v[40:43], v[168:171], v[192:195], v[40:43]
    ds_read_b64_tr_b16 v[132:133], v215 offset:8192
    ds_read_b64_tr_b16 v[134:135], v215 offset:12288
    v_mfma_f32_16x16x32_bf16 v[44:47], v[172:175], v[192:195], v[44:47]
    s_add_u32 s35, s35, 4
    v_mfma_f32_16x16x32_bf16 v[16:19], v[176:179], v[184:187], v[16:19]
    s_cmp_lt_u32 s35, 28
    v_mfma_f32_16x16x32_bf16 v[32:35], v[176:179], v[188:191], v[32:35]
    v_mfma_f32_16x16x32_bf16 v[48:51], v[176:179], v[192:195], v[48:51]
    v_mfma_f32_16x16x32_bf16 v[56:59], v[168:171], v[196:199], v[56:59]
    v_mfma_f32_16x16x32_bf16 v[60:63], v[172:175], v[196:199], v[60:63]
    v_mfma_f32_16x16x32_bf16 v[64:67], v[176:179], v[196:199], v[64:67]
    v_mfma_f32_16x16x32_bf16 v[20:23], v[180:183], v[184:187], v[20:23]
    v_mfma_f32_16x16x32_bf16 v[36:39], v[180:183], v[188:191], v[36:39]
    v_mfma_f32_16x16x32_bf16 v[52:55], v[180:183], v[192:195], v[52:55]
    v_mfma_f32_16x16x32_bf16 v[68:71], v[180:183], v[196:199], v[68:71]
    s_cbranch_scc1 L_g1_cloop
    s_waitcnt lgkmcnt(0)
    s_barrier
    v_mfma_f32_16x16x32_bf16 v[8:11], v[72:75], v[88:91], v[8:11]
    ds_read_b64_tr_b16 v[136:137], v208 offset:32768
    ds_read_b64_tr_b16 v[138:139], v208 offset:36864
    v_mfma_f32_16x16x32_bf16 v[24:27], v[72:75], v[92:95], v[24:27]
    ds_read_b64_tr_b16 v[152:153], v212 offset:32768
    v_mfma_f32_16x16x32_bf16 v[12:15], v[76:79], v[88:91], v[12:15]
    ds_read_b64_tr_b16 v[154:155], v212 offset:36864
    ds_read_b64_tr_b16 v[140:141], v209 offset:32768
    v_mfma_f32_16x16x32_bf16 v[28:31], v[76:79], v[92:95], v[28:31]
    ds_read_b64_tr_b16 v[142:143], v209 offset:36864
    v_mfma_f32_16x16x32_bf16 v[40:43], v[72:75], v[96:99], v[40:43]
    ds_read_b64_tr_b16 v[156:157], v213 offset:32768
    ds_read_b64_tr_b16 v[158:159], v213 offset:36864
    v_mfma_f32_16x16x32_bf16 v[44:47], v[76:79], v[96:99], v[44:47]
    ds_read_b64_tr_b16 v[144:145], v210 offset:32768
    v_mfma_f32_16x16x32_bf16 v[16:19], v[80:83], v[88:91], v[16:19]
    ds_read_b64_tr_b16 v[146:147], v210 offset:36864
    ds_read_b64_tr_b16 v[160:161], v214 offset:32768
    v_mfma_f32_16x16x32_bf16 v[32:35], v[80:83], v[92:95], v[32:35]
    ds_read_b64_tr_b16 v[162:163], v214 offset:36864
    v_mfma_f32_16x16x32_bf16 v[48:51], v[80:83], v[96:99], v[48:51]
    ds_read_b64_tr_b16 v[148:149], v211 offset:32768
    ds_read_b64_tr_b16 v[150:151], v211 offset:36864
    v_mfma_f32_16x16x32_bf16 v[56:59], v[72:75], v[100:103], v[56:59]
    ds_read_b64_tr_b16 v[164:165], v215 offset:32768
    v_mfma_f32_16x16x32_bf16 v[60:63], v[76:79], v[100:103], v[60:63]
    ds_read_b64_tr_b16 v[166:167], v215 offset:36864
    ds_read_b64_tr_b16 v[168:169], v208 offset:40960
    v_mfma_f32_16x16x32_bf16 v[64:67], v[80:83], v[100:103], v[64:67]
    ds_read_b64_tr_b16 v[170:171], v208 offset:45056
    v_mfma_f32_16x16x32_bf16 v[20:23], v[84:87], v[88:91], v[20:23]
    ds_read_b64_tr_b16 v[184:185], v212 offset:40960
    ds_read_b64_tr_b16 v[186:187], v212 offset:45056
    v_mfma_f32_16x16x32_bf16 v[36:39], v[84:87], v[92:95], v[36:39]
    ds_read_b64_tr_b16 v[172:173], v209 offset:40960
    v_mfma_f32_16x16x32_bf16 v[52:55], v[84:87], v[96:99], v[52:55]
    ds_read_b64_tr_b16 v[174:175], v209 offset:45056
    ds_read_b64_tr_b16 v[188:189], v213 offset:40960
    v_mfma_f32_16x16x32_bf16 v[68:71], v[84:87], v[100:103], v[68:71]
    ds_read_b64_tr_b16 v[190:191], v213 offset:45056
    v_mfma_f32_16x16x32_bf16 v[8:11], v[104:107], v[120:123], v[8:11]
    ds_read_b64_tr_b16 v[176:177], v210 offset:40960
    ds_read_b64_tr_b16 v[178:179], v210 offset:45056
    v_mfma_f32_16x16x32_bf16 v[24:27], v[104:107], v[124:127], v[24:27]
    ds_read_b64_tr_b16 v[192:193], v214 offset:40960
    v_mfma_f32_16x16x32_bf16 v[12:15], v[108:111], v[120:123], v[12:15]
    ds_read_b64_tr_b16 v[194:195], v214 offset:45056
    ds_read_b64_tr_b16 v[180:181], v211 offset:40960
    v_mfma_f32_16x16x32_bf16 v[28:31], v[108:111], v[124:127], v[28:31]
    ds_read_b64_tr_b16 v[182:183], v211 offset:45056
    v_mfma_f32_16x16x32_bf16 v[40:43], v[104:107], v[128:131], v[40:43]
    ds_read_b64_tr_b16 v[196:197], v215 offset:40960
    ds_read_b64_tr_b16 v[198:199], v215 offset:45056
    v_mfma_f32_16x16x32_bf16 v[44:47], v[108:111], v[128:131], v[44:47]
    v_mfma_f32_16x16x32_bf16 v[16:19], v[112:115], v[120:123], v[16:19]
    v_mfma_f32_16x16x32_bf16 v[32:35], v[112:115], v[124:127], v[32:35]
    v_mfma_f32_16x16x32_bf16 v[48:51], v[112:115], v[128:131], v[48:51]
    v_mfma_f32_16x16x32_bf16 v[56:59], v[104:107], v[132:135], v[56:59]
    v_mfma_f32_16x16x32_bf16 v[60:63], v[108:111], v[132:135], v[60:63]
    v_mfma_f32_16x16x32_bf16 v[64:67], v[112:115], v[132:135], v[64:67]
    v_mfma_f32_16x16x32_bf16 v[20:23], v[116:119], v[120:123], v[20:23]
    v_mfma_f32_16x16x32_bf16 v[36:39], v[116:119], v[124:127], v[36:39]
    v_mfma_f32_16x16x32_bf16 v[52:55], v[116:119], v[128:131], v[52:55]
    v_mfma_f32_16x16x32_bf16 v[68:71], v[116:119], v[132:135], v[68:71]
    s_waitcnt lgkmcnt(0)
    s_barrier
    v_mfma_f32_16x16x32_bf16 v[8:11], v[136:139], v[152:155], v[8:11]
    ds_read_b64_tr_b16 v[72:73], v200 offset:0
    ds_read_b64_tr_b16 v[74:75], v200 offset:4096
    v_mfma_f32_16x16x32_bf16 v[24:27], v[136:139], v[156:159], v[24:27]
    ds_read_b64_tr_b16 v[88:89], v204 offset:0
    v_mfma_f32_16x16x32_bf16 v[12:15], v[140:143], v[152:155], v[12:15]
    ds_read_b64_tr_b16 v[90:91], v204 offset:4096
    ds_read_b64_tr_b16 v[76:77], v201 offset:0
    v_mfma_f32_16x16x32_bf16 v[28:31], v[140:143], v[156:159], v[28:31]
    ds_read_b64_tr_b16 v[78:79], v201 offset:4096
    v_mfma_f32_16x16x32_bf16 v[40:43], v[136:139], v[160:163], v[40:43]
    ds_read_b64_tr_b16 v[92:93], v205 offset:0
    ds_read_b64_tr_b16 v[94:95], v205 offset:4096
    v_mfma_f32_16x16x32_bf16 v[44:47], v[140:143], v[160:163], v[44:47]
    ds_read_b64_tr_b16 v[80:81], v202 offset:0
    v_mfma_f32_16x16x32_bf16 v[16:19], v[144:147], v[152:155], v[16:19]
    ds_read_b64_tr_b16 v[82:83], v202 offset:4096
    ds_read_b64_tr_b16 v[96:97], v206 offset:0
    v_mfma_f32_16x16x32_bf16 v[32:35], v[144:147], v[156:159], v[32:35]
    ds_read_b64_tr_b16 v[98:99], v206 offset:4096
    v_mfma_f32_16x16x32_bf16 v[48:51], v[144:147], v[160:163], v[48:51]
    ds_read_b64_tr_b16 v[84:85], v203 offset:0
    ds_read_b64_tr_b16 v[86:87], v203 offset:4096
    v_mfma_f32_16x16x32_bf16 v[56:59], v[136:139], v[164:167], v[56:59]
    ds_read_b64_tr_b16 v[100:101], v207 offset:0
    v_mfma_f32_16x16x32_bf16 v[60:63], v[140:143], v[164:167], v[60:63]
    ds_read_b64_tr_b16 v[102:103], v207 offset:4096
    ds_read_b64_tr_b16 v[104:105], v200 offset:8192
    v_mfma_f32_16x16x32_bf16 v[64:67], v[144:147], v[164:167], v[64:67]
    ds_read_b64_tr_b16 v[106:107], v200 offset:12288
    v_mfma_f32_16x16x32_bf16 v[20:23], v[148:151], v[152:155], v[20:23]
    ds_read_b64_tr_b16 v[120:121], v204 offset:8192
    ds_read_b64_tr_b16 v[122:123], v204 offset:12288
    v_mfma_f32_16x16x32_bf16 v[36:39], v[148:151], v[156:159], v[36:39]
    ds_read_b64_tr_b16 v[108:109], v201 offset:8192
    v_mfma_f32_16x16x32_bf16 v[52:55], v[148:151], v[160:163], v[52:55]
    ds_read_b64_tr_b16 v[110:111], v201 offset:12288
    ds_read_b64_tr_b16 v[124:125], v205 offset:8192
    v_mfma_f32_16x16x32_bf16 v[68:71], v[148:151], v[164:167], v[68:71]
    ds_read_b64_tr_b16 v[126:127], v205 offset:12288
    v_mfma_f32_16x16x32_bf16 v[8:11], v[168:171], v[184:187], v[8:11]
    ds_read_b64_tr_b16 v[112:113], v202 offset:8192
    ds_read_b64_tr_b16 v[114:115], v202 offset:12288
    v_mfma_f32_16x16x32_bf16 v[24:27], v[168:171], v[188:191], v[24:27]
    ds_read_b64_tr_b16 v[128:129], v206 offset:8192
    v_mfma_f32_16x16x32_bf16 v[12:15], v[172:175], v[184:187], v[12:15]
    ds_read_b64_tr_b16 v[130:131], v206 offset:12288
    ds_read_b64_tr_b16 v[116:117], v203 offset:8192
    v_mfma_f32_16x16x32_bf16 v[28:31], v[172:175], v[188:191], v[28:31]
    ds_read_b64_tr_b16 v[118:119], v203 offset:12288
    v_mfma_f32_16x16x32_bf16 v[40:43], v[168:171], v[192:195], v[40:43]
    ds_read_b64_tr_b16 v[132:133], v207 offset:8192
    ds_read_b64_tr_b16 v[134:135], v207 offset:12288
    v_mfma_f32_16x16x32_bf16 v[44:47], v[172:175], v[192:195], v[44:47]
    v_mfma_f32_16x16x32_bf16 v[16:19], v[176:179], v[184:187], v[16:19]
    v_mfma_f32_16x16x32_bf16 v[32:35], v[176:179], v[188:191], v[32:35]
    v_mfma_f32_16x16x32_bf16 v[48:51], v[176:179], v[192:195], v[48:51]
    v_mfma_f32_16x16x32_bf16 v[56:59], v[168:171], v[196:199], v[56:59]
    v_mfma_f32_16x16x32_bf16 v[60:63], v[172:175], v[196:199], v[60:63]
    v_mfma_f32_16x16x32_bf16 v[64:67], v[176:179], v[196:199], v[64:67]
    v_mfma_f32_16x16x32_bf16 v[20:23], v[180:183], v[184:187], v[20:23]
    v_mfma_f32_16x16x32_bf16 v[36:39], v[180:183], v[188:191], v[36:39]
    v_mfma_f32_16x16x32_bf16 v[52:55], v[180:183], v[192:195], v[52:55]
    v_mfma_f32_16x16x32_bf16 v[68:71], v[180:183], v[196:199], v[68:71]
    s_waitcnt lgkmcnt(0)
    s_barrier
    v_mfma_f32_16x16x32_bf16 v[8:11], v[72:75], v[88:91], v[8:11]
    ds_read_b64_tr_b16 v[136:137], v200 offset:32768
    ds_read_b64_tr_b16 v[138:139], v200 offset:36864
    v_mfma_f32_16x16x32_bf16 v[24:27], v[72:75], v[92:95], v[24:27]
    ds_read_b64_tr_b16 v[152:153], v204 offset:32768
    v_mfma_f32_16x16x32_bf16 v[12:15], v[76:79], v[88:91], v[12:15]
    ds_read_b64_tr_b16 v[154:155], v204 offset:36864
    ds_read_b64_tr_b16 v[140:141], v201 offset:32768
    v_mfma_f32_16x16x32_bf16 v[28:31], v[76:79], v[92:95], v[28:31]
    ds_read_b64_tr_b16 v[142:143], v201 offset:36864
    v_mfma_f32_16x16x32_bf16 v[40:43], v[72:75], v[96:99], v[40:43]
    ds_read_b64_tr_b16 v[156:157], v205 offset:32768
    ds_read_b64_tr_b16 v[158:159], v205 offset:36864
    v_mfma_f32_16x16x32_bf16 v[44:47], v[76:79], v[96:99], v[44:47]
    ds_read_b64_tr_b16 v[144:145], v202 offset:32768
    v_mfma_f32_16x16x32_bf16 v[16:19], v[80:83], v[88:91], v[16:19]
    ds_read_b64_tr_b16 v[146:147], v202 offset:36864
    ds_read_b64_tr_b16 v[160:161], v206 offset:32768
    v_mfma_f32_16x16x32_bf16 v[32:35], v[80:83], v[92:95], v[32:35]
    ds_read_b64_tr_b16 v[162:163], v206 offset:36864
    v_mfma_f32_16x16x32_bf16 v[48:51], v[80:83], v[96:99], v[48:51]
    ds_read_b64_tr_b16 v[148:149], v203 offset:32768
    ds_read_b64_tr_b16 v[150:151], v203 offset:36864
    v_mfma_f32_16x16x32_bf16 v[56:59], v[72:75], v[100:103], v[56:59]
    ds_read_b64_tr_b16 v[164:165], v207 offset:32768
    v_mfma_f32_16x16x32_bf16 v[60:63], v[76:79], v[100:103], v[60:63]
    ds_read_b64_tr_b16 v[166:167], v207 offset:36864
    ds_read_b64_tr_b16 v[168:169], v200 offset:40960
    v_mfma_f32_16x16x32_bf16 v[64:67], v[80:83], v[100:103], v[64:67]
    ds_read_b64_tr_b16 v[170:171], v200 offset:45056
    v_mfma_f32_16x16x32_bf16 v[20:23], v[84:87], v[88:91], v[20:23]
    ds_read_b64_tr_b16 v[184:185], v204 offset:40960
    ds_read_b64_tr_b16 v[186:187], v204 offset:45056
    v_mfma_f32_16x16x32_bf16 v[36:39], v[84:87], v[92:95], v[36:39]
    ds_read_b64_tr_b16 v[172:173], v201 offset:40960
    v_mfma_f32_16x16x32_bf16 v[52:55], v[84:87], v[96:99], v[52:55]
    ds_read_b64_tr_b16 v[174:175], v201 offset:45056
    ds_read_b64_tr_b16 v[188:189], v205 offset:40960
    v_mfma_f32_16x16x32_bf16 v[68:71], v[84:87], v[100:103], v[68:71]
    ds_read_b64_tr_b16 v[190:191], v205 offset:45056
    v_mfma_f32_16x16x32_bf16 v[8:11], v[104:107], v[120:123], v[8:11]
    ds_read_b64_tr_b16 v[176:177], v202 offset:40960
    ds_read_b64_tr_b16 v[178:179], v202 offset:45056
    v_mfma_f32_16x16x32_bf16 v[24:27], v[104:107], v[124:127], v[24:27]
    ds_read_b64_tr_b16 v[192:193], v206 offset:40960
    v_mfma_f32_16x16x32_bf16 v[12:15], v[108:111], v[120:123], v[12:15]
    ds_read_b64_tr_b16 v[194:195], v206 offset:45056
    ds_read_b64_tr_b16 v[180:181], v203 offset:40960
    v_mfma_f32_16x16x32_bf16 v[28:31], v[108:111], v[124:127], v[28:31]
    ds_read_b64_tr_b16 v[182:183], v203 offset:45056
    v_mfma_f32_16x16x32_bf16 v[40:43], v[104:107], v[128:131], v[40:43]
    ds_read_b64_tr_b16 v[196:197], v207 offset:40960
    ds_read_b64_tr_b16 v[198:199], v207 offset:45056
    v_mfma_f32_16x16x32_bf16 v[44:47], v[108:111], v[128:131], v[44:47]
    v_mfma_f32_16x16x32_bf16 v[16:19], v[112:115], v[120:123], v[16:19]
    v_mfma_f32_16x16x32_bf16 v[32:35], v[112:115], v[124:127], v[32:35]
    v_mfma_f32_16x16x32_bf16 v[48:51], v[112:115], v[128:131], v[48:51]
    v_mfma_f32_16x16x32_bf16 v[56:59], v[104:107], v[132:135], v[56:59]
    v_mfma_f32_16x16x32_bf16 v[60:63], v[108:111], v[132:135], v[60:63]
    v_mfma_f32_16x16x32_bf16 v[64:67], v[112:115], v[132:135], v[64:67]
    v_mfma_f32_16x16x32_bf16 v[20:23], v[116:119], v[120:123], v[20:23]
    v_mfma_f32_16x16x32_bf16 v[36:39], v[116:119], v[124:127], v[36:39]
    v_mfma_f32_16x16x32_bf16 v[52:55], v[116:119], v[128:131], v[52:55]
    v_mfma_f32_16x16x32_bf16 v[68:71], v[116:119], v[132:135], v[68:71]
    s_waitcnt lgkmcnt(0)
    v_mfma_f32_16x16x32_bf16 v[8:11], v[136:139], v[152:155], v[8:11]
    v_mfma_f32_16x16x32_bf16 v[24:27], v[136:139], v[156:159], v[24:27]
    v_mfma_f32_16x16x32_bf16 v[12:15], v[140:143], v[152:155], v[12:15]
    v_mfma_f32_16x16x32_bf16 v[28:31], v[140:143], v[156:159], v[28:31]
    v_mfma_f32_16x16x32_bf16 v[40:43], v[136:139], v[160:163], v[40:43]
    v_mfma_f32_16x16x32_bf16 v[44:47], v[140:143], v[160:163], v[44:47]
    v_mfma_f32_16x16x32_bf16 v[16:19], v[144:147], v[152:155], v[16:19]
    v_mfma_f32_16x16x32_bf16 v[32:35], v[144:147], v[156:159], v[32:35]
    v_mfma_f32_16x16x32_bf16 v[48:51], v[144:147], v[160:163], v[48:51]
    v_mfma_f32_16x16x32_bf16 v[56:59], v[136:139], v[164:167], v[56:59]
    v_mfma_f32_16x16x32_bf16 v[60:63], v[140:143], v[164:167], v[60:63]
    v_mfma_f32_16x16x32_bf16 v[64:67], v[144:147], v[164:167], v[64:67]
    v_mfma_f32_16x16x32_bf16 v[20:23], v[148:151], v[152:155], v[20:23]
    v_mfma_f32_16x16x32_bf16 v[36:39], v[148:151], v[156:159], v[36:39]
    v_mfma_f32_16x16x32_bf16 v[52:55], v[148:151], v[160:163], v[52:55]
    v_mfma_f32_16x16x32_bf16 v[68:71], v[148:151], v[164:167], v[68:71]
    v_mfma_f32_16x16x32_bf16 v[8:11], v[168:171], v[184:187], v[8:11]
    v_mfma_f32_16x16x32_bf16 v[24:27], v[168:171], v[188:191], v[24:27]
    v_mfma_f32_16x16x32_bf16 v[12:15], v[172:175], v[184:187], v[12:15]
    v_mfma_f32_16x16x32_bf16 v[28:31], v[172:175], v[188:191], v[28:31]
    v_mfma_f32_16x16x32_bf16 v[40:43], v[168:171], v[192:195], v[40:43]
    v_mfma_f32_16x16x32_bf16 v[44:47], v[172:175], v[192:195], v[44:47]
    v_mfma_f32_16x16x32_bf16 v[16:19], v[176:179], v[184:187], v[16:19]
    v_mfma_f32_16x16x32_bf16 v[32:35], v[176:179], v[188:191], v[32:35]
    v_mfma_f32_16x16x32_bf16 v[48:51], v[176:179], v[192:195], v[48:51]
    v_mfma_f32_16x16x32_bf16 v[56:59], v[168:171], v[196:199], v[56:59]
    v_mfma_f32_16x16x32_bf16 v[60:63], v[172:175], v[196:199], v[60:63]
    v_mfma_f32_16x16x32_bf16 v[64:67], v[176:179], v[196:199], v[64:67]
    v_mfma_f32_16x16x32_bf16 v[20:23], v[180:183], v[184:187], v[20:23]
    v_mfma_f32_16x16x32_bf16 v[36:39], v[180:183], v[188:191], v[36:39]
    v_mfma_f32_16x16x32_bf16 v[52:55], v[180:183], v[192:195], v[52:55]
    v_mfma_f32_16x16x32_bf16 v[68:71], v[180:183], v[196:199], v[68:71]
    s_mov_b32 s40, 0xffff0000
    s_lshl_b32 s39, s28, 13
    s_add_u32 s39, s39, 65536
    v_lshl_add_u32 v2, v1, 4, s39
    ds_write_b128 v2, v[40:43] offset:0
    ds_write_b128 v2, v[44:47] offset:1024
    ds_write_b128 v2, v[48:51] offset:2048
    ds_write_b128 v2, v[52:55] offset:3072
    ds_write_b128 v2, v[56:59] offset:4096
    ds_write_b128 v2, v[60:63] offset:5120
    ds_write_b128 v2, v[64:67] offset:6144
    ds_write_b128 v2, v[68:71] offset:7168
    s_waitcnt vmcnt(0) lgkmcnt(0)
    s_barrier
L_g1_epi:
    v_lshlrev_b32 v216, 16, v216
    v_lshlrev_b32 v217, 16, v217
    s_mov_b32 s40, 0xffff0000
    s_mov_b32 s42, 0xbdd2d3e8
    v_mov_b32 v4, 0xc0135761
    v_mov_b32 v5, 0xc0135761
    v_mov_b32 v6, 1.0
    v_mov_b32 v7, 1.0
    v_and_b32 v2, 7, v1
    v_lshlrev_b32 v2, 11, v2
    v_bfe_u32 v3, v1, 3, 1
    v_lshl_add_u32 v2, v3, 6, v2
    v_lshrrev_b32 v3, 4, v1
    v_lshl_add_u32 v3, v3, 4, v2
    v_add_f32 v80, v8, v216
    v_add_f32 v81, v9, v216
    v_pk_mul_f32 v[82:83], v[80:81], v[80:81]
    v_pk_fma_f32 v[82:83], v[82:83], s[42:43], v[4:5] op_sel_hi:[1,0,1]
    v_pk_mul_f32 v[82:83], v[82:83], v[80:81]
    v_exp_f32 v82, v82
    v_exp_f32 v83, v83
    s_nop 0
    v_pk_add_f32 v[82:83], v[82:83], v[6:7]
    v_rcp_f32 v82, v82
    v_rcp_f32 v83, v83
    s_nop 0
    v_pk_mul_f32 v[82:83], v[82:83], v[80:81]
    v_cvt_pk_bf16_f32 v72, v82, v83
    v_add_f32 v84, v10, v216
    v_add_f32 v85, v11, v216
    v_pk_mul_f32 v[86:87], v[84:85], v[84:85]
    v_pk_fma_f32 v[86:87], v[86:87], s[42:43], v[4:5] op_sel_hi:[1,0,1]
    v_pk_mul_f32 v[86:87], v[86:87], v[84:85]
    v_exp_f32 v86, v86
    v_exp_f32 v87, v87
    s_nop 0
    v_pk_add_f32 v[86:87], v[86:87], v[6:7]
    v_rcp_f32 v86, v86
    v_rcp_f32 v87, v87
    s_nop 0
    v_pk_mul_f32 v[86:87], v[86:87], v[84:85]
    v_cvt_pk_bf16_f32 v73, v86, v87
    v_add_f32 v88, v12, v216
    v_add_f32 v89, v13, v216
    v_pk_mul_f32 v[90:91], v[88:89], v[88:89]
    v_pk_fma_f32 v[90:91], v[90:91], s[42:43], v[4:5] op_sel_hi:[1,0,1]
    v_pk_mul_f32 v[90:91], v[90:91], v[88:89]
    v_exp_f32 v90, v90
    v_exp_f32 v91, v91
    s_nop 0
    v_pk_add_f32 v[90:91], v[90:91], v[6:7]
    v_rcp_f32 v90, v90
    v_rcp_f32 v91, v91
    s_nop 0
    v_pk_mul_f32 v[90:91], v[90:91], v[88:89]
    v_cvt_pk_bf16_f32 v74, v90, v91
    v_add_f32 v92, v14, v216
    v_add_f32 v93, v15, v216
    v_pk_mul_f32 v[94:95], v[92:93], v[92:93]
    v_pk_fma_f32 v[94:95], v[94:95], s[42:43], v[4:5] op_sel_hi:[1,0,1]
    v_pk_mul_f32 v[94:95], v[94:95], v[92:93]
    v_exp_f32 v94, v94
    v_exp_f32 v95, v95
    s_nop 0
    v_pk_add_f32 v[94:95], v[94:95], v[6:7]
    v_rcp_f32 v94, v94
    v_rcp_f32 v95, v95
    s_nop 0
    v_pk_mul_f32 v[94:95], v[94:95], v[92:93]
    v_cvt_pk_bf16_f32 v75, v94, v95
    v_permlane32_swap_b32 v72, v74
    s_nop 0
    v_permlane32_swap_b32 v73, v75
    v_permlane16_swap_b32 v72, v74
    s_nop 0
    v_permlane16_swap_b32 v73, v75
    v_add_f32 v80, v16, v216
    v_add_f32 v81, v17, v216
    v_pk_mul_f32 v[82:83], v[80:81], v[80:81]
    v_pk_fma_f32 v[82:83], v[82:83], s[42:43], v[4:5] op_sel_hi:[1,0,1]
    v_pk_mul_f32 v[82:83], v[82:83], v[80:81]
    v_exp_f32 v82, v82
    v_exp_f32 v83, v83
    s_nop 0
    v_pk_add_f32 v[82:83], v[82:83], v[6:7]
    v_rcp_f32 v82, v82
    v_rcp_f32 v83, v83
    s_nop 0
    v_pk_mul_f32 v[82:83], v[82:83], v[80:81]
    v_cvt_pk_bf16_f32 v76, v82, v83
    v_add_f32 v84, v18, v216
    v_add_f32 v85, v19, v216
    v_pk_mul_f32 v[86:87], v[84:85], v[84:85]
    v_pk_fma_f32 v[86:87], v[86:87], s[42:43], v[4:5] op_sel_hi:[1,0,1]
    v_pk_mul_f32 v[86:87], v[86:87], v[84:85]
    v_exp_f32 v86, v86
    v_exp_f32 v87, v87
    s_nop 0
    v_pk_add_f32 v[86:87], v[86:87], v[6:7]
    v_rcp_f32 v86, v86
    v_rcp_f32 v87, v87
    s_nop 0
    v_pk_mul_f32 v[86:87], v[86:87], v[84:85]
    v_cvt_pk_bf16_f32 v77, v86, v87
    v_add_f32 v88, v20, v216
    v_add_f32 v89, v21, v216
    v_pk_mul_f32 v[90:91], v[88:89], v[88:89]
    v_pk_fma_f32 v[90:91], v[90:91], s[42:43], v[4:5] op_sel_hi:[1,0,1]
    v_pk_mul_f32 v[90:91], v[90:91], v[88:89]
    v_exp_f32 v90, v90
    v_exp_f32 v91, v91
    s_nop 0
    v_pk_add_f32 v[90:91], v[90:91], v[6:7]
    v_rcp_f32 v90, v90
    v_rcp_f32 v91, v91
    s_nop 0
    v_pk_mul_f32 v[90:91], v[90:91], v[88:89]
    v_cvt_pk_bf16_f32 v78, v90, v91
    v_add_f32 v92, v22, v216
    v_add_f32 v93, v23, v216
    v_pk_mul_f32 v[94:95], v[92:93], v[92:93]
    v_pk_fma_f32 v[94:95], v[94:95], s[42:43], v[4:5] op_sel_hi:[1,0,1]
    v_pk_mul_f32 v[94:95], v[94:95], v[92:93]
    v_exp_f32 v94, v94
    v_exp_f32 v95, v95
    s_nop 0
    v_pk_add_f32 v[94:95], v[94:95], v[6:7]
    v_rcp_f32 v94, v94
    v_rcp_f32 v95, v95
    s_nop 0
    v_pk_mul_f32 v[94:95], v[94:95], v[92:93]
    v_cvt_pk_bf16_f32 v79, v94, v95
    v_permlane32_swap_b32 v76, v78
    s_nop 0
    v_permlane32_swap_b32 v77, v79
    v_permlane16_swap_b32 v76, v78
    s_nop 0
    v_permlane16_swap_b32 v77, v79
    v_mov_b32 v104, v72
    v_mov_b32 v105, v73
    v_mov_b32 v106, v74
    v_mov_b32 v107, v75
    v_mov_b32_dpp v72, v76 row_ror:8 row_mask:0xf bank_mask:0xc
    v_mov_b32_dpp v73, v77 row_ror:8 row_mask:0xf bank_mask:0xc
    v_mov_b32_dpp v74, v78 row_ror:8 row_mask:0xf bank_mask:0xc
    v_mov_b32_dpp v75, v79 row_ror:8 row_mask:0xf bank_mask:0xc
    v_mov_b32_dpp v76, v104 row_ror:8 row_mask:0xf bank_mask:0x3
    v_mov_b32_dpp v77, v105 row_ror:8 row_mask:0xf bank_mask:0x3
    v_mov_b32_dpp v78, v106 row_ror:8 row_mask:0xf bank_mask:0x3
    v_mov_b32_dpp v79, v107 row_ror:8 row_mask:0xf bank_mask:0x3
    s_add_u32 s41, s38, 0
    buffer_store_dwordx4 v[72:75], v3, s[16:19], s41 offen sc1
    s_add_u32 s41, s38, 16384
    buffer_store_dwordx4 v[76:79], v3, s[16:19], s41 offen sc1
    v_add_f32 v80, v24, v217
    v_add_f32 v81, v25, v217
    v_pk_mul_f32 v[82:83], v[80:81], v[80:81]
    v_pk_fma_f32 v[82:83], v[82:83], s[42:43], v[4:5] op_sel_hi:[1,0,1]
    v_pk_mul_f32 v[82:83], v[82:83], v[80:81]
    v_exp_f32 v82, v82
    v_exp_f32 v83, v83
    s_nop 0
    v_pk_add_f32 v[82:83], v[82:83], v[6:7]
    v_rcp_f32 v82, v82
    v_rcp_f32 v83, v83
    s_nop 0
    v_pk_mul_f32 v[82:83], v[82:83], v[80:81]
    v_cvt_pk_bf16_f32 v96, v82, v83
    v_add_f32 v84, v26, v217
    v_add_f32 v85, v27, v217
    v_pk_mul_f32 v[86:87], v[84:85], v[84:85]
    v_pk_fma_f32 v[86:87], v[86:87], s[42:43], v[4:5] op_sel_hi:[1,0,1]
    v_pk_mul_f32 v[86:87], v[86:87], v[84:85]
    v_exp_f32 v86, v86
    v_exp_f32 v87, v87
    s_nop 0
    v_pk_add_f32 v[86:87], v[86:87], v[6:7]
    v_rcp_f32 v86, v86
    v_rcp_f32 v87, v87
    s_nop 0
    v_pk_mul_f32 v[86:87], v[86:87], v[84:85]
    v_cvt_pk_bf16_f32 v97, v86, v87
    v_add_f32 v88, v28, v217
    v_add_f32 v89, v29, v217
    v_pk_mul_f32 v[90:91], v[88:89], v[88:89]
    v_pk_fma_f32 v[90:91], v[90:91], s[42:43], v[4:5] op_sel_hi:[1,0,1]
    v_pk_mul_f32 v[90:91], v[90:91], v[88:89]
    v_exp_f32 v90, v90
    v_exp_f32 v91, v91
    s_nop 0
    v_pk_add_f32 v[90:91], v[90:91], v[6:7]
    v_rcp_f32 v90, v90
    v_rcp_f32 v91, v91
    s_nop 0
    v_pk_mul_f32 v[90:91], v[90:91], v[88:89]
    v_cvt_pk_bf16_f32 v98, v90, v91
    v_add_f32 v92, v30, v217
    v_add_f32 v93, v31, v217
    v_pk_mul_f32 v[94:95], v[92:93], v[92:93]
    v_pk_fma_f32 v[94:95], v[94:95], s[42:43], v[4:5] op_sel_hi:[1,0,1]
    v_pk_mul_f32 v[94:95], v[94:95], v[92:93]
    v_exp_f32 v94, v94
    v_exp_f32 v95, v95
    s_nop 0
    v_pk_add_f32 v[94:95], v[94:95], v[6:7]
    v_rcp_f32 v94, v94
    v_rcp_f32 v95, v95
    s_nop 0
    v_pk_mul_f32 v[94:95], v[94:95], v[92:93]
    v_cvt_pk_bf16_f32 v99, v94, v95
    v_permlane32_swap_b32 v96, v98
    s_nop 0
    v_permlane32_swap_b32 v97, v99
    v_permlane16_swap_b32 v96, v98
    s_nop 0
    v_permlane16_swap_b32 v97, v99
    v_add_f32 v80, v32, v217
    v_add_f32 v81, v33, v217
    v_pk_mul_f32 v[82:83], v[80:81], v[80:81]
    v_pk_fma_f32 v[82:83], v[82:83], s[42:43], v[4:5] op_sel_hi:[1,0,1]
    v_pk_mul_f32 v[82:83], v[82:83], v[80:81]
    v_exp_f32 v82, v82
    v_exp_f32 v83, v83
    s_nop 0
    v_pk_add_f32 v[82:83], v[82:83], v[6:7]
    v_rcp_f32 v82, v82
    v_rcp_f32 v83, v83
    s_nop 0
    v_pk_mul_f32 v[82:83], v[82:83], v[80:81]
    v_cvt_pk_bf16_f32 v100, v82, v83
    v_add_f32 v84, v34, v217
    v_add_f32 v85, v35, v217
    v_pk_mul_f32 v[86:87], v[84:85], v[84:85]
    v_pk_fma_f32 v[86:87], v[86:87], s[42:43], v[4:5] op_sel_hi:[1,0,1]
    v_pk_mul_f32 v[86:87], v[86:87], v[84:85]
    v_exp_f32 v86, v86
    v_exp_f32 v87, v87
    s_nop 0
    v_pk_add_f32 v[86:87], v[86:87], v[6:7]
    v_rcp_f32 v86, v86
    v_rcp_f32 v87, v87
    s_nop 0
    v_pk_mul_f32 v[86:87], v[86:87], v[84:85]
    v_cvt_pk_bf16_f32 v101, v86, v87
    v_add_f32 v88, v36, v217
    v_add_f32 v89, v37, v217
    v_pk_mul_f32 v[90:91], v[88:89], v[88:89]
    v_pk_fma_f32 v[90:91], v[90:91], s[42:43], v[4:5] op_sel_hi:[1,0,1]
    v_pk_mul_f32 v[90:91], v[90:91], v[88:89]
    v_exp_f32 v90, v90
    v_exp_f32 v91, v91
    s_nop 0
    v_pk_add_f32 v[90:91], v[90:91], v[6:7]
    v_rcp_f32 v90, v90
    v_rcp_f32 v91, v91
    s_nop 0
    v_pk_mul_f32 v[90:91], v[90:91], v[88:89]
    v_cvt_pk_bf16_f32 v102, v90, v91
    v_add_f32 v92, v38, v217
    v_add_f32 v93, v39, v217
    v_pk_mul_f32 v[94:95], v[92:93], v[92:93]
    v_pk_fma_f32 v[94:95], v[94:95], s[42:43], v[4:5] op_sel_hi:[1,0,1]
    v_pk_mul_f32 v[94:95], v[94:95], v[92:93]
    v_exp_f32 v94, v94
    v_exp_f32 v95, v95
    s_nop 0
    v_pk_add_f32 v[94:95], v[94:95], v[6:7]
    v_rcp_f32 v94, v94
    v_rcp_f32 v95, v95
    s_nop 0
    v_pk_mul_f32 v[94:95], v[94:95], v[92:93]
    v_cvt_pk_bf16_f32 v103, v94, v95
    v_permlane32_swap_b32 v100, v102
    s_nop 0
    v_permlane32_swap_b32 v101, v103
    v_permlane16_swap_b32 v100, v102
    s_nop 0
    v_permlane16_swap_b32 v101, v103
    v_mov_b32 v104, v96
    v_mov_b32 v105, v97
    v_mov_b32 v106, v98
    v_mov_b32 v107, v99
    v_mov_b32_dpp v96, v100 row_ror:8 row_mask:0xf bank_mask:0xc
    v_mov_b32_dpp v97, v101 row_ror:8 row_mask:0xf bank_mask:0xc
    v_mov_b32_dpp v98, v102 row_ror:8 row_mask:0xf bank_mask:0xc
    v_mov_b32_dpp v99, v103 row_ror:8 row_mask:0xf bank_mask:0xc
    v_mov_b32_dpp v100, v104 row_ror:8 row_mask:0xf bank_mask:0x3
    v_mov_b32_dpp v101, v105 row_ror:8 row_mask:0xf bank_mask:0x3
    v_mov_b32_dpp v102, v106 row_ror:8 row_mask:0xf bank_mask:0x3
    v_mov_b32_dpp v103, v107 row_ror:8 row_mask:0xf bank_mask:0x3
    s_add_u32 s41, s38, 32768
    buffer_store_dwordx4 v[96:99], v3, s[16:19], s41 offen sc1
    s_add_u32 s41, s38, 49152
    buffer_store_dwordx4 v[100:103], v3, s[16:19], s41 offen sc1
    s_branch L_gbar
L_g1_prod:
    s_setprio 3
    s_sub_u32 s33, s28, 4
    v_lshrrev_b32 v2, 4, v1
    s_and_b32 s34, s33, 1
    s_lshl_b32 s34, s34, 2
    v_add_u32 v3, s34, v2
    v_lshlrev_b32 v3, 1, v3
    v_and_b32 v4, 15, v1
    v_xor_b32 v3, v3, v4
    v_lshlrev_b32 v3, 4, v3
    v_lshl_add_u32 v8, v2, 11, v3
    v_mul_u32_u24 v2, 7168, v2
    v_add_u32 v9, v2, v3
    s_lshl_b32 s34, s33, 13
    s_add_u32 s40, s32, s34
    s_mul_i32 s34, s33, 28672
    s_add_u32 s41, s31, s34
    s_lshl_b32 s42, s33, 10
    s_mov_b32 s43, 0
    s_add_u32 s46, s52, s53
    s_mov_b32 s47, 0
    s_add_u32 s36, s26, 0x2830000
    s_addc_u32 s37, s27, 0
    s_mov_b32 s38, 0x8000
    s_mov_b32 s39, 0x20000
    v_and_b32 v11, 31, v1
    v_lshlrev_b32 v11, 7, v11
    s_barrier
    s_barrier
    s_barrier
    s_barrier
    s_barrier
    s_barrier
    s_add_u32 s58, s46, s47
    s_and_b32 s58, s58, 3
    s_cmp_eq_u32 s58, 0
    s_cselect_b32 s58, 35, 31
    s_add_u32 s58, s58, s47
    s_add_u32 s58, s58, s55
    s_cmp_ge_u32 s58, 64
    s_cselect_b32 s59, 64, 32
    s_cmp_ge_u32 s58, 32
    s_cselect_b32 s59, s59, 0
    s_sub_u32 s58, s58, s59
    s_add_u32 s58, s58, s63
    s_mul_i32 s59, s58, 458752
    s_lshl_b32 s58, s58, 17
    s_add_u32 s58, s58, s40
    s_add_u32 s59, s59, s41
    s_add_u32 s44, s43, s42
    s_add_u32 m0, s44, 16384
    s_add_u32 s45, s59, 0
    buffer_load_dwordx4 v9, s[8:11], s45 offen  lds
    s_add_u32 m0, s44, 20480
    s_add_u32 s45, s59, 114688
    buffer_load_dwordx4 v9, s[8:11], s45 offen  lds
    s_add_u32 m0, s44, 24576
    s_add_u32 s45, s59, 229376
    buffer_load_dwordx4 v9, s[8:11], s45 offen  lds
    s_add_u32 m0, s44, 28672
    s_add_u32 s45, s59, 344064
    buffer_load_dwordx4 v9, s[8:11], s45 offen  lds
    s_add_u32 s47, s47, 1
    s_add_u32 s43, s43, 32768
    s_cmp_eq_u32 s43, 131072
    s_cselect_b32 s43, 0, s43
    s_add_u32 s58, s46, s47
    s_and_b32 s58, s58, 3
    s_cmp_eq_u32 s58, 0
    s_cselect_b32 s58, 35, 31
    s_add_u32 s58, s58, s47
    s_add_u32 s58, s58, s55
    s_cmp_ge_u32 s58, 64
    s_cselect_b32 s59, 64, 32
    s_cmp_ge_u32 s58, 32
    s_cselect_b32 s59, s59, 0
    s_sub_u32 s58, s58, s59
    s_add_u32 s58, s58, s63
    s_mul_i32 s59, s58, 458752
    s_lshl_b32 s58, s58, 17
    s_add_u32 s58, s58, s40
    s_add_u32 s59, s59, s41
    s_add_u32 s44, s43, s42
    s_add_u32 m0, s44, 16384
    s_add_u32 s45, s59, 0
    buffer_load_dwordx4 v9, s[8:11], s45 offen  lds
    s_add_u32 m0, s44, 20480
    s_add_u32 s45, s59, 114688
    buffer_load_dwordx4 v9, s[8:11], s45 offen  lds
    s_add_u32 m0, s44, 24576
    s_add_u32 s45, s59, 229376
    buffer_load_dwordx4 v9, s[8:11], s45 offen  lds
    s_add_u32 m0, s44, 28672
    s_add_u32 s45, s59, 344064
    buffer_load_dwordx4 v9, s[8:11], s45 offen  lds
    s_add_u32 s47, s47, 1
    s_add_u32 s43, s43, 32768
    s_cmp_eq_u32 s43, 131072
    s_cselect_b32 s43, 0, s43
    s_mov_b32 s47, 0
    s_mov_b32 s43, 0
    s_cmp_eq_u32 s33, 0
    s_cbranch_scc0 L_g1_hpre
    s_mov_b32 s61, 0
    s_add_u32 s56, s46, s61
    s_and_b32 s56, s56, 3
    s_cmp_eq_u32 s56, 0
    s_cselect_b32 s56, 35, 31
    s_add_u32 s56, s56, s61
    s_add_u32 s56, s56, s55
    s_cmp_ge_u32 s56, 64
    s_cselect_b32 s59, 64, 32
    s_cmp_ge_u32 s56, 32
    s_cselect_b32 s59, s59, 0
    s_sub_u32 s56, s56, s59
    s_add_u32 s56, s56, s63
    s_bfe_u32 s54, s56, 0x30001
    s_lshl_b32 s54, s54, 12
    s_mov_b32 s61, 1
    s_add_u32 s56, s46, s61
    s_and_b32 s56, s56, 3
    s_cmp_eq_u32 s56, 0
    s_cselect_b32 s56, 35, 31
    s_add_u32 s56, s56, s61
    s_add_u32 s56, s56, s55
    s_cmp_ge_u32 s56, 64
    s_cselect_b32 s59, 64, 32
    s_cmp_ge_u32 s56, 32
    s_cselect_b32 s59, s59, 0
    s_sub_u32 s56, s56, s59
    s_add_u32 s56, s56, s63
    s_bfe_u32 s57, s56, 0x30001
    s_lshl_b32 s57, s57, 12
    v_mov_b32 v12, s54
    v_mov_b32 v13, s57
    v_cmp_gt_u32 vcc, 32, v1
    s_nop 1
    v_cndmask_b32 v12, v13, v12, vcc
    v_add_u32 v12, v12, v11
    s_mov_b32 s61, 0
L_g1_hsp:
    buffer_load_dword v10, v12, s[36:39], 0 offen sc0 sc1
    s_waitcnt vmcnt(0)
    v_cmp_eq_u32 vcc, 0, v10
    s_add_u32 s61, s61, 1
    s_cmp_ge_u32 s61, 0x20000
    s_cbranch_scc1 L_g1_hsd
    s_nop 2
    s_cbranch_vccnz L_g1_hsp
L_g1_hsd:
    s_mov_b32 s61, 2
    s_add_u32 s56, s46, s61
    s_and_b32 s56, s56, 3
    s_cmp_eq_u32 s56, 0
    s_cselect_b32 s56, 35, 31
    s_add_u32 s56, s56, s61
    s_add_u32 s56, s56, s55
    s_cmp_ge_u32 s56, 64
    s_cselect_b32 s59, 64, 32
    s_cmp_ge_u32 s56, 32
    s_cselect_b32 s59, s59, 0
    s_sub_u32 s56, s56, s59
    s_add_u32 s56, s56, s63
    s_bfe_u32 s54, s56, 0x30001
    s_lshl_b32 s54, s54, 12
    buffer_load_dword v10, v11, s[36:39], s54 offen sc0 sc1
L_g1_hpre:
    s_barrier
    s_add_u32 s58, s46, s47
    s_and_b32 s58, s58, 3
    s_cmp_eq_u32 s58, 0
    s_cselect_b32 s58, 35, 31
    s_add_u32 s58, s58, s47
    s_add_u32 s58, s58, s55
    s_cmp_ge_u32 s58, 64
    s_cselect_b32 s59, 64, 32
    s_cmp_ge_u32 s58, 32
    s_cselect_b32 s59, s59, 0
    s_sub_u32 s58, s58, s59
    s_add_u32 s58, s58, s63
    s_mul_i32 s59, s58, 458752
    s_lshl_b32 s58, s58, 17
    s_add_u32 s58, s58, s40
    s_add_u32 s59, s59, s41
    s_add_u32 s44, s43, s42
    s_add_u32 m0, s44, 0
    s_add_u32 s45, s58, 0
    buffer_load_dwordx4 v8, s[12:15], s45 offen sc1 lds
    s_add_u32 m0, s44, 4096
    s_add_u32 s45, s58, 32768
    buffer_load_dwordx4 v8, s[12:15], s45 offen sc1 lds
    s_add_u32 m0, s44, 8192
    s_add_u32 s45, s58, 65536
    buffer_load_dwordx4 v8, s[12:15], s45 offen sc1 lds
    s_add_u32 m0, s44, 12288
    s_add_u32 s45, s58, 98304
    buffer_load_dwordx4 v8, s[12:15], s45 offen sc1 lds
    s_add_u32 s47, s47, 1
    s_add_u32 s43, s43, 32768
    s_cmp_eq_u32 s43, 131072
    s_cselect_b32 s43, 0, s43
    s_add_u32 s58, s46, s47
    s_and_b32 s58, s58, 3
    s_cmp_eq_u32 s58, 0
    s_cselect_b32 s58, 35, 31
    s_add_u32 s58, s58, s47
    s_add_u32 s58, s58, s55
    s_cmp_ge_u32 s58, 64
    s_cselect_b32 s59, 64, 32
    s_cmp_ge_u32 s58, 32
    s_cselect_b32 s59, s59, 0
    s_sub_u32 s58, s58, s59
    s_add_u32 s58, s58, s63
    s_mul_i32 s59, s58, 458752
    s_lshl_b32 s58, s58, 17
    s_add_u32 s58, s58, s40
    s_add_u32 s59, s59, s41
    s_add_u32 s44, s43, s42
    s_add_u32 m0, s44, 0
    s_add_u32 s45, s58, 0
    buffer_load_dwordx4 v8, s[12:15], s45 offen sc1 lds
    s_add_u32 m0, s44, 4096
    s_add_u32 s45, s58, 32768
    buffer_load_dwordx4 v8, s[12:15], s45 offen sc1 lds
    s_add_u32 m0, s44, 8192
    s_add_u32 s45, s58, 65536
    buffer_load_dwordx4 v8, s[12:15], s45 offen sc1 lds
    s_add_u32 m0, s44, 12288
    s_add_u32 s45, s58, 98304
    buffer_load_dwordx4 v8, s[12:15], s45 offen sc1 lds
    s_add_u32 s47, s47, 1
    s_add_u32 s43, s43, 32768
    s_cmp_eq_u32 s43, 131072
    s_cselect_b32 s43, 0, s43
    s_waitcnt vmcnt(4)
    s_cmp_eq_u32 s33, 0
    s_cbranch_scc0 L_g1_hc0
    s_mov_b32 s61, 0
L_g1_hpc0:
    v_cmp_eq_u32 vcc, 0, v10
    s_add_u32 s61, s61, 1
    s_cmp_ge_u32 s61, 0x20000
    s_cbranch_scc1 L_g1_hdc0
    s_nop 2
    s_cbranch_vccz L_g1_hdc0
    s_sleep 2
    buffer_load_dword v10, v11, s[36:39], s54 offen sc0 sc1
    s_waitcnt vmcnt(0)
    s_branch L_g1_hpc0
L_g1_hdc0:
L_g1_hc0:
    s_barrier
    s_cmp_eq_u32 s33, 0
    s_cbranch_scc0 L_g1_nh4
    s_add_u32 s61, s47, 1
    s_add_u32 s56, s46, s61
    s_and_b32 s56, s56, 3
    s_cmp_eq_u32 s56, 0
    s_cselect_b32 s56, 35, 31
    s_add_u32 s56, s56, s61
    s_add_u32 s56, s56, s55
    s_cmp_ge_u32 s56, 64
    s_cselect_b32 s59, 64, 32
    s_cmp_ge_u32 s56, 32
    s_cselect_b32 s59, s59, 0
    s_sub_u32 s56, s56, s59
    s_add_u32 s56, s56, s63
    s_bfe_u32 s54, s56, 0x30001
    s_lshl_b32 s54, s54, 12
    buffer_load_dword v10, v11, s[36:39], s54 offen sc0 sc1
L_g1_nh4:
    s_add_u32 s58, s46, s47
    s_and_b32 s58, s58, 3
    s_cmp_eq_u32 s58, 0
    s_cselect_b32 s58, 35, 31
    s_add_u32 s58, s58, s47
    s_add_u32 s58, s58, s55
    s_cmp_ge_u32 s58, 64
    s_cselect_b32 s59, 64, 32
    s_cmp_ge_u32 s58, 32
    s_cselect_b32 s59, s59, 0
    s_sub_u32 s58, s58, s59
    s_add_u32 s58, s58, s63
    s_mul_i32 s59, s58, 458752
    s_lshl_b32 s58, s58, 17
    s_add_u32 s58, s58, s40
    s_add_u32 s59, s59, s41
    s_add_u32 s44, s43, s42
    s_add_u32 m0, s44, 0
    s_add_u32 s45, s58, 0
    buffer_load_dwordx4 v8, s[12:15], s45 offen sc1 lds
    s_add_u32 m0, s44, 16384
    s_add_u32 s45, s59, 0
    buffer_load_dwordx4 v9, s[8:11], s45 offen  lds
    s_add_u32 m0, s44, 4096
    s_add_u32 s45, s58, 32768
    buffer_load_dwordx4 v8, s[12:15], s45 offen sc1 lds
    s_add_u32 m0, s44, 20480
    s_add_u32 s45, s59, 114688
    buffer_load_dwordx4 v9, s[8:11], s45 offen  lds
    s_add_u32 m0, s44, 8192
    s_add_u32 s45, s58, 65536
    buffer_load_dwordx4 v8, s[12:15], s45 offen sc1 lds
    s_add_u32 m0, s44, 24576
    s_add_u32 s45, s59, 229376
    buffer_load_dwordx4 v9, s[8:11], s45 offen  lds
    s_add_u32 m0, s44, 12288
    s_add_u32 s45, s58, 98304
    buffer_load_dwordx4 v8, s[12:15], s45 offen sc1 lds
    s_add_u32 m0, s44, 28672
    s_add_u32 s45, s59, 344064
    buffer_load_dwordx4 v9, s[8:11], s45 offen  lds
    s_add_u32 s47, s47, 1
    s_add_u32 s43, s43, 32768
    s_cmp_eq_u32 s43, 131072
    s_cselect_b32 s43, 0, s43
    s_mov_b32 s60, 0
L_g1_ploop:
    s_waitcnt vmcnt(8)
    s_cmp_eq_u32 s33, 0
    s_cbranch_scc0 L_g1_hc1
    s_mov_b32 s61, 0
L_g1_hpc1:
    v_cmp_eq_u32 vcc, 0, v10
    s_add_u32 s61, s61, 1
    s_cmp_ge_u32 s61, 0x20000
    s_cbranch_scc1 L_g1_hdc1
    s_nop 2
    s_cbranch_vccz L_g1_hdc1
    s_sleep 2
    buffer_load_dword v10, v11, s[36:39], s54 offen sc0 sc1
    s_waitcnt vmcnt(0)
    s_branch L_g1_hpc1
L_g1_hdc1:
L_g1_hc1:
    s_barrier
    s_cmp_eq_u32 s33, 0
    s_cbranch_scc0 L_g1_nh5
    s_add_u32 s61, s47, 1
    s_add_u32 s56, s46, s61
    s_and_b32 s56, s56, 3
    s_cmp_eq_u32 s56, 0
    s_cselect_b32 s56, 35, 31
    s_add_u32 s56, s56, s61
    s_add_u32 s56, s56, s55
    s_cmp_ge_u32 s56, 64
    s_cselect_b32 s59, 64, 32
    s_cmp_ge_u32 s56, 32
    s_cselect_b32 s59, s59, 0
    s_sub_u32 s56, s56, s59
    s_add_u32 s56, s56, s63
    s_bfe_u32 s54, s56, 0x30001
    s_lshl_b32 s54, s54, 12
    buffer_load_dword v10, v11, s[36:39], s54 offen sc0 sc1
L_g1_nh5:
    s_add_u32 s58, s46, s47
    s_and_b32 s58, s58, 3
    s_cmp_eq_u32 s58, 0
    s_cselect_b32 s58, 35, 31
    s_add_u32 s58, s58, s47
    s_add_u32 s58, s58, s55
    s_cmp_ge_u32 s58, 64
    s_cselect_b32 s59, 64, 32
    s_cmp_ge_u32 s58, 32
    s_cselect_b32 s59, s59, 0
    s_sub_u32 s58, s58, s59
    s_add_u32 s58, s58, s63
    s_mul_i32 s59, s58, 458752
    s_lshl_b32 s58, s58, 17
    s_add_u32 s58, s58, s40
    s_add_u32 s59, s59, s41
    s_add_u32 s44, s43, s42
    s_add_u32 m0, s44, 0
    s_add_u32 s45, s58, 0
    buffer_load_dwordx4 v8, s[12:15], s45 offen sc1 lds
    s_add_u32 m0, s44, 16384
    s_add_u32 s45, s59, 0
    buffer_load_dwordx4 v9, s[8:11], s45 offen  lds
    s_add_u32 m0, s44, 4096
    s_add_u32 s45, s58, 32768
    buffer_load_dwordx4 v8, s[12:15], s45 offen sc1 lds
    s_add_u32 m0, s44, 20480
    s_add_u32 s45, s59, 114688
    buffer_load_dwordx4 v9, s[8:11], s45 offen  lds
    s_add_u32 m0, s44, 8192
    s_add_u32 s45, s58, 65536
    buffer_load_dwordx4 v8, s[12:15], s45 offen sc1 lds
    s_add_u32 m0, s44, 24576
    s_add_u32 s45, s59, 229376
    buffer_load_dwordx4 v9, s[8:11], s45 offen  lds
    s_add_u32 m0, s44, 12288
    s_add_u32 s45, s58, 98304
    buffer_load_dwordx4 v8, s[12:15], s45 offen sc1 lds
    s_add_u32 m0, s44, 28672
    s_add_u32 s45, s59, 344064
    buffer_load_dwordx4 v9, s[8:11], s45 offen  lds
    s_add_u32 s47, s47, 1
    s_add_u32 s43, s43, 32768
    s_cmp_eq_u32 s43, 131072
    s_cselect_b32 s43, 0, s43
    s_add_u32 s60, s60, 1
    s_cmp_lt_u32 s60, 29
    s_cbranch_scc1 L_g1_ploop
    s_waitcnt vmcnt(8)
    s_barrier
    s_waitcnt vmcnt(0)
    s_barrier
    s_cmp_eq_u32 s33, 0
    s_cbranch_scc0 L_g1_nonp
    s_getpc_b64 s[56:57]
L_g1_npc:
    s_add_u32 s56, s56, L_gbar-L_g1_npc
    s_addc_u32 s57, s57, 0
    s_lshr_b32 s58, s2, 3
    s_mul_i32 s58, s58, ((L_text_end-L_gbar)/128+28)/28
    v_add_u32 v122, s58, v1
    v_lshlrev_b32 v122, 7, v122
    v_mov_b32 v121, s57
    v_add_co_u32 v120, vcc, s56, v122
    s_nop 1
    v_addc_co_u32 v121, vcc, 0, v121, vcc
    v_cmp_gt_u32 vcc, ((L_text_end-L_gbar)/128+28)/28, v1
    s_nop 0
    s_mov_b64 exec, vcc
    v_cmp_gt_u32 vcc, L_text_end-L_gbar, v122
    s_nop 0
    s_and_b64 exec, exec, vcc
    s_cbranch_execz L_g1_npe
    global_load_dword v123, v[120:121], off
L_g1_npe:
    s_mov_b64 exec, -1
L_g1_nonp:
    s_and_b32 s34, s33, 1
    s_lshr_b32 s36, s33, 1
    v_and_b32 v2, 15, v1
    v_lshlrev_b32 v2, 1, v2
    s_lshl_b32 s37, s36, 7
    s_add_u32 s37, s37, s31
    buffer_load_ushort v216, v2, s[20:23], s37 offen offset:64
    buffer_load_ushort v217, v2, s[20:23], s37 offen offset:96
    v_and_b32 v2, 15, v1
    v_lshlrev_b32 v2, 11, v2
    v_lshrrev_b32 v3, 4, v1
    v_lshl_add_u32 v220, v3, 4, v2
    s_lshl_b32 s38, s29, 7
    s_lshl_b32 s39, s36, 6
    s_add_u32 s38, s38, s39
    s_add_u32 s38, s38, 32
    s_lshl_b32 s38, s38, 11
    s_add_u32 s38, s38, s32
    s_lshl_b32 s39, s34, 7
    s_add_u32 s38, s38, s39
    s_lshl_b32 s39, s33, 13
    s_add_u32 s39, s39, 65536
    v_lshl_add_u32 v2, v1, 4, s39
    s_setprio 0
    s_barrier
    ds_read_b128 v[8:11], v2 offset:0
    ds_read_b128 v[12:15], v2 offset:1024
    ds_read_b128 v[16:19], v2 offset:2048
    ds_read_b128 v[20:23], v2 offset:3072
    ds_read_b128 v[24:27], v2 offset:4096
    ds_read_b128 v[28:31], v2 offset:5120
    ds_read_b128 v[32:35], v2 offset:6144
    ds_read_b128 v[36:39], v2 offset:7168
    s_waitcnt vmcnt(0) lgkmcnt(0)
    s_branch L_g1_epi
L_gbar:
    s_lshl_b32 s3, s30, 5
    s_add_u32 s3, s3, s29
    s_lshl_b32 s3, s3, 7
L_g2start:
    s_cmp_ge_u32 s28, 4
    s_cbranch_scc1 L_g2_pro
    s_waitcnt vmcnt(0)
    s_barrier
    s_cmp_eq_u32 s3, -1
    s_cbranch_scc1 L_g2_pro
    s_add_u32 s56, s26, 0x2820000
    s_addc_u32 s57, s27, 0
    s_mov_b32 s58, 0x9000
    s_mov_b32 s59, 0x20000
    v_mov_b32 v2, 1
    v_mov_b32 v3, 0
    v_cmp_eq_u32 vcc, 0, v0
    s_nop 0
    s_and_saveexec_b64 s[44:45], vcc
    s_cbranch_execz L_g2_nopubx
    buffer_store_dword v2, v3, s[56:59], s3 offen sc0 sc1
L_g2_nopubx:
    s_mov_b64 exec, -1
L_g2_pro:
    s_load_dwordx4 s[4:7], s[0:1], 48
    s_load_dwordx2 s[24:25], s[0:1], 64
    s_load_dwordx2 s[26:27], s[0:1], 80
    v_and_b32 v1, 63, v0
    v_lshrrev_b32 v2, 6, v0
    s_nop 0
    v_readfirstlane_b32 s28, v2
    s_bfe_u32 s62, s2, 0x10002
    s_bfe_u32 s52, s2, 0x20003
    s_lshr_b32 s53, s2, 5
    s_and_b32 s30, s2, 1
    s_lshl_b32 s30, s30, 2
    s_add_u32 s30, s30, s52
    s_bfe_u32 s34, s2, 0x10001
    s_lshl_b32 s29, s34, 3
    s_add_u32 s29, s29, s53
    s_mov_b32 s55, 0
    s_mul_i32 s55, s34, 7
    s_add_u32 s55, s55, s53
    s_lshl_b32 s55, s55, 1
    s_add_u32 s55, s55, 1
    s_cmp_ge_u32 s55, 28
    s_cselect_b32 s34, 28, 0
    s_sub_u32 s55, s55, s34
    s_mul_i32 s63, s62, 28
    s_lshl_b32 s31, s29, 8
    s_lshl_b32 s32, s30, 8
    s_waitcnt lgkmcnt(0)
    s_mov_b32 s8, s4
    s_mov_b32 s9, s5
    s_mov_b32 s10, 0xe00000
    s_mov_b32 s11, 0x20000
    s_add_u32 s12, s26, 0x1600000
    s_addc_u32 s13, s27, 0
    s_mov_b32 s14, 0x700000
    s_mov_b32 s15, 0x20000
    s_add_u32 s16, s26, 0xe00000
    s_addc_u32 s17, s27, 0
    s_mov_b32 s18, 0x400000
    s_mov_b32 s19, 0x20000
    s_mov_b32 s20, s6
    s_mov_b32 s21, s7
    s_mov_b32 s22, 0x1000
    s_mov_b32 s23, 0x20000
    s_mov_b32 s48, s24
    s_mov_b32 s49, s25
    s_mov_b32 s50, 0x400000
    s_mov_b32 s51, 0x20000
    s_cmp_ge_u32 s28, 4
    s_cbranch_scc1 L_g2_prod
L_g2_cons:
    s_and_b32 s33, s28, 1
    s_lshr_b32 s36, s28, 1
    v_lshrrev_b32 v2, 4, v1
    v_bfe_u32 v3, v1, 2, 2
    v_and_b32 v4, 3, v1
    v_lshl_add_u32 v5, v2, 2, v3
    v_and_b32 v6, 7, v5
    v_lshlrev_b32 v6, 1, v6
    v_lshrrev_b32 v7, 1, v4
    v_and_b32 v9, 1, v4
    s_lshl_b32 s35, s33, 3
    v_add_u32 v10, s35, v7
    v_xor_b32 v10, v10, v6
    v_lshlrev_b32 v10, 4, v10
    v_lshl_add_u32 v10, v9, 3, v10
    v_lshl_add_u32 v10, v5, 8, v10
    v_mov_b32 v208, v10
    v_xor_b32 v209, 32, v10
    v_xor_b32 v210, 64, v10
    v_xor_b32 v211, 96, v10
    s_lshl_b32 s35, s36, 3
    v_add_u32 v10, s35, v7
    v_xor_b32 v10, v10, v6
    v_lshlrev_b32 v10, 4, v10
    v_lshl_add_u32 v10, v9, 3, v10
    v_lshl_add_u32 v10, v5, 8, v10
    v_add_u32 v10, 16384, v10
    v_mov_b32 v212, v10
    v_xor_b32 v213, 32, v10
    v_xor_b32 v214, 64, v10
    v_xor_b32 v215, 96, v10
    v_mov_b32 v200, v208
    v_mov_b32 v204, v212
    v_mov_b32 v201, v209
    v_mov_b32 v205, v213
    v_mov_b32 v202, v210
    v_mov_b32 v206, v214
    v_mov_b32 v203, v211
    v_mov_b32 v207, v215
    v_and_b32 v2, 15, v1
    v_lshlrev_b32 v2, 1, v2
    s_lshl_b32 s37, s36, 7
    s_add_u32 s37, s37, s31
    buffer_load_ushort v216, v2, s[20:23], s37 offen offset:0
    buffer_load_ushort v217, v2, s[20:23], s37 offen offset:32
    buffer_load_ushort v218, v2, s[20:23], s37 offen offset:64
    buffer_load_ushort v219, v2, s[20:23], s37 offen offset:96
    v_and_b32 v2, 15, v1
    v_lshlrev_b32 v2, 11, v2
    v_lshrrev_b32 v3, 4, v1
    v_lshl_add_u32 v220, v3, 4, v2
    s_lshl_b32 s38, s29, 7
    s_lshl_b32 s39, s36, 6
    s_add_u32 s38, s38, s39
    s_lshl_b32 s38, s38, 11
    s_add_u32 s38, s38, s32
    s_lshl_b32 s39, s33, 7
    s_add_u32 s38, s38, s39
    v_mov_b32 v8, 0
    v_mov_b32 v9, 0
    v_mov_b32 v10, 0
    v_mov_b32 v11, 0
    v_mov_b32 v12, 0
    v_mov_b32 v13, 0
    v_mov_b32 v14, 0
    v_mov_b32 v15, 0
    v_mov_b32 v16, 0
    v_mov_b32 v17, 0
    v_mov_b32 v18, 0
    v_mov_b32 v19, 0
    v_mov_b32 v20, 0
    v_mov_b32 v21, 0
    v_mov_b32 v22, 0
    v_mov_b32 v23, 0
    v_mov_b32 v24, 0
    v_mov_b32 v25, 0
    v_mov_b32 v26, 0
    v_mov_b32 v27, 0
    v_mov_b32 v28, 0
    v_mov_b32 v29, 0
    v_mov_b32 v30, 0
    v_mov_b32 v31, 0
    v_mov_b32 v32, 0
    v_mov_b32 v33, 0
    v_mov_b32 v34, 0
    v_mov_b32 v35, 0
    v_mov_b32 v36, 0
    v_mov_b32 v37, 0
    v_mov_b32 v38, 0
    v_mov_b32 v39, 0
    v_mov_b32 v40, 0
    v_mov_b32 v41, 0
    v_mov_b32 v42, 0
    v_mov_b32 v43, 0
    v_mov_b32 v44, 0
    v_mov_b32 v45, 0
    v_mov_b32 v46, 0
    v_mov_b32 v47, 0
    v_mov_b32 v48, 0
    v_mov_b32 v49, 0
    v_mov_b32 v50, 0
    v_mov_b32 v51, 0
    v_mov_b32 v52, 0
    v_mov_b32 v53, 0
    v_mov_b32 v54, 0
    v_mov_b32 v55, 0
    v_mov_b32 v56, 0
    v_mov_b32 v57, 0
    v_mov_b32 v58, 0
    v_mov_b32 v59, 0
    v_mov_b32 v60, 0
    v_mov_b32 v61, 0
    v_mov_b32 v62, 0
    v_mov_b32 v63, 0
    v_mov_b32 v64, 0
    v_mov_b32 v65, 0
    v_mov_b32 v66, 0
    v_mov_b32 v67, 0
    v_mov_b32 v68, 0
    v_mov_b32 v69, 0
    v_mov_b32 v70, 0
    v_mov_b32 v71, 0
    s_mov_b32 s34, 0
    s_mov_b32 s35, 0
    s_barrier
    v_add_u32 v200, 65536, v208
    v_add_u32 v204, 65536, v212
    v_add_u32 v201, 65536, v209
    v_add_u32 v205, 65536, v213
    v_add_u32 v202, 65536, v210
    v_add_u32 v206, 65536, v214
    v_add_u32 v203, 65536, v211
    v_add_u32 v207, 65536, v215
    ds_read_b64_tr_b16 v[72:73], v208 offset:0
    ds_read_b64_tr_b16 v[74:75], v208 offset:4096
    ds_read_b64_tr_b16 v[88:89], v212 offset:0
    ds_read_b64_tr_b16 v[90:91], v212 offset:4096
    ds_read_b64_tr_b16 v[76:77], v209 offset:0
    ds_read_b64_tr_b16 v[78:79], v209 offset:4096
    ds_read_b64_tr_b16 v[92:93], v213 offset:0
    ds_read_b64_tr_b16 v[94:95], v213 offset:4096
    ds_read_b64_tr_b16 v[80:81], v210 offset:0
    ds_read_b64_tr_b16 v[82:83], v210 offset:4096
    ds_read_b64_tr_b16 v[96:97], v214 offset:0
    ds_read_b64_tr_b16 v[98:99], v214 offset:4096
    ds_read_b64_tr_b16 v[84:85], v211 offset:0
    ds_read_b64_tr_b16 v[86:87], v211 offset:4096
    ds_read_b64_tr_b16 v[100:101], v215 offset:0
    ds_read_b64_tr_b16 v[102:103], v215 offset:4096
    ds_read_b64_tr_b16 v[104:105], v208 offset:8192
    ds_read_b64_tr_b16 v[106:107], v208 offset:12288
    ds_read_b64_tr_b16 v[120:121], v212 offset:8192
    ds_read_b64_tr_b16 v[122:123], v212 offset:12288
    ds_read_b64_tr_b16 v[108:109], v209 offset:8192
    ds_read_b64_tr_b16 v[110:111], v209 offset:12288
    ds_read_b64_tr_b16 v[124:125], v213 offset:8192
    ds_read_b64_tr_b16 v[126:127], v213 offset:12288
    ds_read_b64_tr_b16 v[112:113], v210 offset:8192
    ds_read_b64_tr_b16 v[114:115], v210 offset:12288
    ds_read_b64_tr_b16 v[128:129], v214 offset:8192
    ds_read_b64_tr_b16 v[130:131], v214 offset:12288
    ds_read_b64_tr_b16 v[116:117], v211 offset:8192
    ds_read_b64_tr_b16 v[118:119], v211 offset:12288
    ds_read_b64_tr_b16 v[132:133], v215 offset:8192
    ds_read_b64_tr_b16 v[134:135], v215 offset:12288
L_g2_cloop:
    s_waitcnt lgkmcnt(0)
    s_barrier
    v_mfma_f32_16x16x32_bf16 v[8:11], v[72:75], v[88:91], v[8:11]
    ds_read_b64_tr_b16 v[136:137], v208 offset:32768
    ds_read_b64_tr_b16 v[138:139], v208 offset:36864
    v_mfma_f32_16x16x32_bf16 v[24:27], v[72:75], v[92:95], v[24:27]
    ds_read_b64_tr_b16 v[152:153], v212 offset:32768
    v_mfma_f32_16x16x32_bf16 v[12:15], v[76:79], v[88:91], v[12:15]
    ds_read_b64_tr_b16 v[154:155], v212 offset:36864
    ds_read_b64_tr_b16 v[140:141], v209 offset:32768
    v_mfma_f32_16x16x32_bf16 v[28:31], v[76:79], v[92:95], v[28:31]
    ds_read_b64_tr_b16 v[142:143], v209 offset:36864
    v_mfma_f32_16x16x32_bf16 v[40:43], v[72:75], v[96:99], v[40:43]
    ds_read_b64_tr_b16 v[156:157], v213 offset:32768
    ds_read_b64_tr_b16 v[158:159], v213 offset:36864
    v_mfma_f32_16x16x32_bf16 v[44:47], v[76:79], v[96:99], v[44:47]
    ds_read_b64_tr_b16 v[144:145], v210 offset:32768
    v_mfma_f32_16x16x32_bf16 v[16:19], v[80:83], v[88:91], v[16:19]
    ds_read_b64_tr_b16 v[146:147], v210 offset:36864
    ds_read_b64_tr_b16 v[160:161], v214 offset:32768
    v_mfma_f32_16x16x32_bf16 v[32:35], v[80:83], v[92:95], v[32:35]
    ds_read_b64_tr_b16 v[162:163], v214 offset:36864
    v_mfma_f32_16x16x32_bf16 v[48:51], v[80:83], v[96:99], v[48:51]
    ds_read_b64_tr_b16 v[148:149], v211 offset:32768
    ds_read_b64_tr_b16 v[150:151], v211 offset:36864
    v_mfma_f32_16x16x32_bf16 v[56:59], v[72:75], v[100:103], v[56:59]
    ds_read_b64_tr_b16 v[164:165], v215 offset:32768
    v_mfma_f32_16x16x32_bf16 v[60:63], v[76:79], v[100:103], v[60:63]
    ds_read_b64_tr_b16 v[166:167], v215 offset:36864
    ds_read_b64_tr_b16 v[168:169], v208 offset:40960
    v_mfma_f32_16x16x32_bf16 v[64:67], v[80:83], v[100:103], v[64:67]
    ds_read_b64_tr_b16 v[170:171], v208 offset:45056
    v_mfma_f32_16x16x32_bf16 v[20:23], v[84:87], v[88:91], v[20:23]
    ds_read_b64_tr_b16 v[184:185], v212 offset:40960
    ds_read_b64_tr_b16 v[186:187], v212 offset:45056
    v_mfma_f32_16x16x32_bf16 v[36:39], v[84:87], v[92:95], v[36:39]
    ds_read_b64_tr_b16 v[172:173], v209 offset:40960
    v_mfma_f32_16x16x32_bf16 v[52:55], v[84:87], v[96:99], v[52:55]
    ds_read_b64_tr_b16 v[174:175], v209 offset:45056
    ds_read_b64_tr_b16 v[188:189], v213 offset:40960
    v_mfma_f32_16x16x32_bf16 v[68:71], v[84:87], v[100:103], v[68:71]
    ds_read_b64_tr_b16 v[190:191], v213 offset:45056
    v_mfma_f32_16x16x32_bf16 v[8:11], v[104:107], v[120:123], v[8:11]
    ds_read_b64_tr_b16 v[176:177], v210 offset:40960
    ds_read_b64_tr_b16 v[178:179], v210 offset:45056
    v_mfma_f32_16x16x32_bf16 v[24:27], v[104:107], v[124:127], v[24:27]
    ds_read_b64_tr_b16 v[192:193], v214 offset:40960
    v_mfma_f32_16x16x32_bf16 v[12:15], v[108:111], v[120:123], v[12:15]
    ds_read_b64_tr_b16 v[194:195], v214 offset:45056
    ds_read_b64_tr_b16 v[180:181], v211 offset:40960
    v_mfma_f32_16x16x32_bf16 v[28:31], v[108:111], v[124:127], v[28:31]
    ds_read_b64_tr_b16 v[182:183], v211 offset:45056
    v_mfma_f32_16x16x32_bf16 v[40:43], v[104:107], v[128:131], v[40:43]
    ds_read_b64_tr_b16 v[196:197], v215 offset:40960
    ds_read_b64_tr_b16 v[198:199], v215 offset:45056
    v_mfma_f32_16x16x32_bf16 v[44:47], v[108:111], v[128:131], v[44:47]
    v_mfma_f32_16x16x32_bf16 v[16:19], v[112:115], v[120:123], v[16:19]
    v_mfma_f32_16x16x32_bf16 v[32:35], v[112:115], v[124:127], v[32:35]
    v_mfma_f32_16x16x32_bf16 v[48:51], v[112:115], v[128:131], v[48:51]
    v_mfma_f32_16x16x32_bf16 v[56:59], v[104:107], v[132:135], v[56:59]
    v_mfma_f32_16x16x32_bf16 v[60:63], v[108:111], v[132:135], v[60:63]
    v_mfma_f32_16x16x32_bf16 v[64:67], v[112:115], v[132:135], v[64:67]
    v_mfma_f32_16x16x32_bf16 v[20:23], v[116:119], v[120:123], v[20:23]
    v_mfma_f32_16x16x32_bf16 v[36:39], v[116:119], v[124:127], v[36:39]
    v_mfma_f32_16x16x32_bf16 v[52:55], v[116:119], v[128:131], v[52:55]
    v_mfma_f32_16x16x32_bf16 v[68:71], v[116:119], v[132:135], v[68:71]
    s_waitcnt lgkmcnt(0)
    s_barrier
    v_mfma_f32_16x16x32_bf16 v[8:11], v[136:139], v[152:155], v[8:11]
    ds_read_b64_tr_b16 v[72:73], v200 offset:0
    ds_read_b64_tr_b16 v[74:75], v200 offset:4096
    v_mfma_f32_16x16x32_bf16 v[24:27], v[136:139], v[156:159], v[24:27]
    ds_read_b64_tr_b16 v[88:89], v204 offset:0
    v_mfma_f32_16x16x32_bf16 v[12:15], v[140:143], v[152:155], v[12:15]
    ds_read_b64_tr_b16 v[90:91], v204 offset:4096
    ds_read_b64_tr_b16 v[76:77], v201 offset:0
    v_mfma_f32_16x16x32_bf16 v[28:31], v[140:143], v[156:159], v[28:31]
    ds_read_b64_tr_b16 v[78:79], v201 offset:4096
    v_mfma_f32_16x16x32_bf16 v[40:43], v[136:139], v[160:163], v[40:43]
    ds_read_b64_tr_b16 v[92:93], v205 offset:0
    ds_read_b64_tr_b16 v[94:95], v205 offset:4096
    v_mfma_f32_16x16x32_bf16 v[44:47], v[140:143], v[160:163], v[44:47]
    ds_read_b64_tr_b16 v[80:81], v202 offset:0
    v_mfma_f32_16x16x32_bf16 v[16:19], v[144:147], v[152:155], v[16:19]
    ds_read_b64_tr_b16 v[82:83], v202 offset:4096
    ds_read_b64_tr_b16 v[96:97], v206 offset:0
    v_mfma_f32_16x16x32_bf16 v[32:35], v[144:147], v[156:159], v[32:35]
    ds_read_b64_tr_b16 v[98:99], v206 offset:4096
    v_mfma_f32_16x16x32_bf16 v[48:51], v[144:147], v[160:163], v[48:51]
    ds_read_b64_tr_b16 v[84:85], v203 offset:0
    ds_read_b64_tr_b16 v[86:87], v203 offset:4096
    v_mfma_f32_16x16x32_bf16 v[56:59], v[136:139], v[164:167], v[56:59]
    ds_read_b64_tr_b16 v[100:101], v207 offset:0
    v_mfma_f32_16x16x32_bf16 v[60:63], v[140:143], v[164:167], v[60:63]
    ds_read_b64_tr_b16 v[102:103], v207 offset:4096
    ds_read_b64_tr_b16 v[104:105], v200 offset:8192
    v_mfma_f32_16x16x32_bf16 v[64:67], v[144:147], v[164:167], v[64:67]
    ds_read_b64_tr_b16 v[106:107], v200 offset:12288
    v_mfma_f32_16x16x32_bf16 v[20:23], v[148:151], v[152:155], v[20:23]
    ds_read_b64_tr_b16 v[120:121], v204 offset:8192
    ds_read_b64_tr_b16 v[122:123], v204 offset:12288
    v_mfma_f32_16x16x32_bf16 v[36:39], v[148:151], v[156:159], v[36:39]
    ds_read_b64_tr_b16 v[108:109], v201 offset:8192
    v_mfma_f32_16x16x32_bf16 v[52:55], v[148:151], v[160:163], v[52:55]
    ds_read_b64_tr_b16 v[110:111], v201 offset:12288
    ds_read_b64_tr_b16 v[124:125], v205 offset:8192
    v_mfma_f32_16x16x32_bf16 v[68:71], v[148:151], v[164:167], v[68:71]
    ds_read_b64_tr_b16 v[126:127], v205 offset:12288
    v_mfma_f32_16x16x32_bf16 v[8:11], v[168:171], v[184:187], v[8:11]
    ds_read_b64_tr_b16 v[112:113], v202 offset:8192
    ds_read_b64_tr_b16 v[114:115], v202 offset:12288
    v_mfma_f32_16x16x32_bf16 v[24:27], v[168:171], v[188:191], v[24:27]
    ds_read_b64_tr_b16 v[128:129], v206 offset:8192
    v_mfma_f32_16x16x32_bf16 v[12:15], v[172:175], v[184:187], v[12:15]
    ds_read_b64_tr_b16 v[130:131], v206 offset:12288
    ds_read_b64_tr_b16 v[116:117], v203 offset:8192
    v_mfma_f32_16x16x32_bf16 v[28:31], v[172:175], v[188:191], v[28:31]
    ds_read_b64_tr_b16 v[118:119], v203 offset:12288
    v_mfma_f32_16x16x32_bf16 v[40:43], v[168:171], v[192:195], v[40:43]
    ds_read_b64_tr_b16 v[132:133], v207 offset:8192
    ds_read_b64_tr_b16 v[134:135], v207 offset:12288
    v_mfma_f32_16x16x32_bf16 v[44:47], v[172:175], v[192:195], v[44:47]
    v_mfma_f32_16x16x32_bf16 v[16:19], v[176:179], v[184:187], v[16:19]
    v_mfma_f32_16x16x32_bf16 v[32:35], v[176:179], v[188:191], v[32:35]
    v_mfma_f32_16x16x32_bf16 v[48:51], v[176:179], v[192:195], v[48:51]
    v_mfma_f32_16x16x32_bf16 v[56:59], v[168:171], v[196:199], v[56:59]
    v_mfma_f32_16x16x32_bf16 v[60:63], v[172:175], v[196:199], v[60:63]
    v_mfma_f32_16x16x32_bf16 v[64:67], v[176:179], v[196:199], v[64:67]
    v_mfma_f32_16x16x32_bf16 v[20:23], v[180:183], v[184:187], v[20:23]
    v_mfma_f32_16x16x32_bf16 v[36:39], v[180:183], v[188:191], v[36:39]
    v_mfma_f32_16x16x32_bf16 v[52:55], v[180:183], v[192:195], v[52:55]
    v_mfma_f32_16x16x32_bf16 v[68:71], v[180:183], v[196:199], v[68:71]
    s_waitcnt lgkmcnt(0)
    s_barrier
    v_mfma_f32_16x16x32_bf16 v[8:11], v[72:75], v[88:91], v[8:11]
    ds_read_b64_tr_b16 v[136:137], v200 offset:32768
    ds_read_b64_tr_b16 v[138:139], v200 offset:36864
    v_mfma_f32_16x16x32_bf16 v[24:27], v[72:75], v[92:95], v[24:27]
    ds_read_b64_tr_b16 v[152:153], v204 offset:32768
    v_mfma_f32_16x16x32_bf16 v[12:15], v[76:79], v[88:91], v[12:15]
    ds_read_b64_tr_b16 v[154:155], v204 offset:36864
    ds_read_b64_tr_b16 v[140:141], v201 offset:32768
    v_mfma_f32_16x16x32_bf16 v[28:31], v[76:79], v[92:95], v[28:31]
    ds_read_b64_tr_b16 v[142:143], v201 offset:36864
    v_mfma_f32_16x16x32_bf16 v[40:43], v[72:75], v[96:99], v[40:43]
    ds_read_b64_tr_b16 v[156:157], v205 offset:32768
    ds_read_b64_tr_b16 v[158:159], v205 offset:36864
    v_mfma_f32_16x16x32_bf16 v[44:47], v[76:79], v[96:99], v[44:47]
    ds_read_b64_tr_b16 v[144:145], v202 offset:32768
    v_mfma_f32_16x16x32_bf16 v[16:19], v[80:83], v[88:91], v[16:19]
    ds_read_b64_tr_b16 v[146:147], v202 offset:36864
    ds_read_b64_tr_b16 v[160:161], v206 offset:32768
    v_mfma_f32_16x16x32_bf16 v[32:35], v[80:83], v[92:95], v[32:35]
    ds_read_b64_tr_b16 v[162:163], v206 offset:36864
    v_mfma_f32_16x16x32_bf16 v[48:51], v[80:83], v[96:99], v[48:51]
    ds_read_b64_tr_b16 v[148:149], v203 offset:32768
    ds_read_b64_tr_b16 v[150:151], v203 offset:36864
    v_mfma_f32_16x16x32_bf16 v[56:59], v[72:75], v[100:103], v[56:59]
    ds_read_b64_tr_b16 v[164:165], v207 offset:32768
    v_mfma_f32_16x16x32_bf16 v[60:63], v[76:79], v[100:103], v[60:63]
    ds_read_b64_tr_b16 v[166:167], v207 offset:36864
    ds_read_b64_tr_b16 v[168:169], v200 offset:40960
    v_mfma_f32_16x16x32_bf16 v[64:67], v[80:83], v[100:103], v[64:67]
    ds_read_b64_tr_b16 v[170:171], v200 offset:45056
    v_mfma_f32_16x16x32_bf16 v[20:23], v[84:87], v[88:91], v[20:23]
    ds_read_b64_tr_b16 v[184:185], v204 offset:40960
    ds_read_b64_tr_b16 v[186:187], v204 offset:45056
    v_mfma_f32_16x16x32_bf16 v[36:39], v[84:87], v[92:95], v[36:39]
    ds_read_b64_tr_b16 v[172:173], v201 offset:40960
    v_mfma_f32_16x16x32_bf16 v[52:55], v[84:87], v[96:99], v[52:55]
    ds_read_b64_tr_b16 v[174:175], v201 offset:45056
    ds_read_b64_tr_b16 v[188:189], v205 offset:40960
    v_mfma_f32_16x16x32_bf16 v[68:71], v[84:87], v[100:103], v[68:71]
    ds_read_b64_tr_b16 v[190:191], v205 offset:45056
    v_mfma_f32_16x16x32_bf16 v[8:11], v[104:107], v[120:123], v[8:11]
    ds_read_b64_tr_b16 v[176:177], v202 offset:40960
    ds_read_b64_tr_b16 v[178:179], v202 offset:45056
    v_mfma_f32_16x16x32_bf16 v[24:27], v[104:107], v[124:127], v[24:27]
    ds_read_b64_tr_b16 v[192:193], v206 offset:40960
    v_mfma_f32_16x16x32_bf16 v[12:15], v[108:111], v[120:123], v[12:15]
    ds_read_b64_tr_b16 v[194:195], v206 offset:45056
    ds_read_b64_tr_b16 v[180:181], v203 offset:40960
    v_mfma_f32_16x16x32_bf16 v[28:31], v[108:111], v[124:127], v[28:31]
    ds_read_b64_tr_b16 v[182:183], v203 offset:45056
    v_mfma_f32_16x16x32_bf16 v[40:43], v[104:107], v[128:131], v[40:43]
    ds_read_b64_tr_b16 v[196:197], v207 offset:40960
    ds_read_b64_tr_b16 v[198:199], v207 offset:45056
    v_mfma_f32_16x16x32_bf16 v[44:47], v[108:111], v[128:131], v[44:47]
    v_mfma_f32_16x16x32_bf16 v[16:19], v[112:115], v[120:123], v[16:19]
    v_mfma_f32_16x16x32_bf16 v[32:35], v[112:115], v[124:127], v[32:35]
    v_mfma_f32_16x16x32_bf16 v[48:51], v[112:115], v[128:131], v[48:51]
    v_mfma_f32_16x16x32_bf16 v[56:59], v[104:107], v[132:135], v[56:59]
    v_mfma_f32_16x16x32_bf16 v[60:63], v[108:111], v[132:135], v[60:63]
    v_mfma_f32_16x16x32_bf16 v[64:67], v[112:115], v[132:135], v[64:67]
    v_mfma_f32_16x16x32_bf16 v[20:23], v[116:119], v[120:123], v[20:23]
    v_mfma_f32_16x16x32_bf16 v[36:39], v[116:119], v[124:127], v[36:39]
    v_mfma_f32_16x16x32_bf16 v[52:55], v[116:119], v[128:131], v[52:55]
    v_mfma_f32_16x16x32_bf16 v[68:71], v[116:119], v[132:135], v[68:71]
    s_waitcnt lgkmcnt(0)
    s_barrier
    v_mfma_f32_16x16x32_bf16 v[8:11], v[136:139], v[152:155], v[8:11]
    ds_read_b64_tr_b16 v[72:73], v208 offset:0
    ds_read_b64_tr_b16 v[74:75], v208 offset:4096
    v_mfma_f32_16x16x32_bf16 v[24:27], v[136:139], v[156:159], v[24:27]
    ds_read_b64_tr_b16 v[88:89], v212 offset:0
    v_mfma_f32_16x16x32_bf16 v[12:15], v[140:143], v[152:155], v[12:15]
    ds_read_b64_tr_b16 v[90:91], v212 offset:4096
    ds_read_b64_tr_b16 v[76:77], v209 offset:0
    v_mfma_f32_16x16x32_bf16 v[28:31], v[140:143], v[156:159], v[28:31]
    ds_read_b64_tr_b16 v[78:79], v209 offset:4096
    v_mfma_f32_16x16x32_bf16 v[40:43], v[136:139], v[160:163], v[40:43]
    ds_read_b64_tr_b16 v[92:93], v213 offset:0
    ds_read_b64_tr_b16 v[94:95], v213 offset:4096
    v_mfma_f32_16x16x32_bf16 v[44:47], v[140:143], v[160:163], v[44:47]
    ds_read_b64_tr_b16 v[80:81], v210 offset:0
    v_mfma_f32_16x16x32_bf16 v[16:19], v[144:147], v[152:155], v[16:19]
    ds_read_b64_tr_b16 v[82:83], v210 offset:4096
    ds_read_b64_tr_b16 v[96:97], v214 offset:0
    v_mfma_f32_16x16x32_bf16 v[32:35], v[144:147], v[156:159], v[32:35]
    ds_read_b64_tr_b16 v[98:99], v214 offset:4096
    v_mfma_f32_16x16x32_bf16 v[48:51], v[144:147], v[160:163], v[48:51]
    ds_read_b64_tr_b16 v[84:85], v211 offset:0
    ds_read_b64_tr_b16 v[86:87], v211 offset:4096
    v_mfma_f32_16x16x32_bf16 v[56:59], v[136:139], v[164:167], v[56:59]
    ds_read_b64_tr_b16 v[100:101], v215 offset:0
    v_mfma_f32_16x16x32_bf16 v[60:63], v[140:143], v[164:167], v[60:63]
    ds_read_b64_tr_b16 v[102:103], v215 offset:4096
    ds_read_b64_tr_b16 v[104:105], v208 offset:8192
    v_mfma_f32_16x16x32_bf16 v[64:67], v[144:147], v[164:167], v[64:67]
    ds_read_b64_tr_b16 v[106:107], v208 offset:12288
    v_mfma_f32_16x16x32_bf16 v[20:23], v[148:151], v[152:155], v[20:23]
    ds_read_b64_tr_b16 v[120:121], v212 offset:8192
    ds_read_b64_tr_b16 v[122:123], v212 offset:12288
    v_mfma_f32_16x16x32_bf16 v[36:39], v[148:151], v[156:159], v[36:39]
    ds_read_b64_tr_b16 v[108:109], v209 offset:8192
    v_mfma_f32_16x16x32_bf16 v[52:55], v[148:151], v[160:163], v[52:55]
    ds_read_b64_tr_b16 v[110:111], v209 offset:12288
    ds_read_b64_tr_b16 v[124:125], v213 offset:8192
    v_mfma_f32_16x16x32_bf16 v[68:71], v[148:151], v[164:167], v[68:71]
    ds_read_b64_tr_b16 v[126:127], v213 offset:12288
    v_mfma_f32_16x16x32_bf16 v[8:11], v[168:171], v[184:187], v[8:11]
    ds_read_b64_tr_b16 v[112:113], v210 offset:8192
    ds_read_b64_tr_b16 v[114:115], v210 offset:12288
    v_mfma_f32_16x16x32_bf16 v[24:27], v[168:171], v[188:191], v[24:27]
    ds_read_b64_tr_b16 v[128:129], v214 offset:8192
    v_mfma_f32_16x16x32_bf16 v[12:15], v[172:175], v[184:187], v[12:15]
    ds_read_b64_tr_b16 v[130:131], v214 offset:12288
    ds_read_b64_tr_b16 v[116:117], v211 offset:8192
    v_mfma_f32_16x16x32_bf16 v[28:31], v[172:175], v[188:191], v[28:31]
    ds_read_b64_tr_b16 v[118:119], v211 offset:12288
    v_mfma_f32_16x16x32_bf16 v[40:43], v[168:171], v[192:195], v[40:43]
    ds_read_b64_tr_b16 v[132:133], v215 offset:8192
    ds_read_b64_tr_b16 v[134:135], v215 offset:12288
    v_mfma_f32_16x16x32_bf16 v[44:47], v[172:175], v[192:195], v[44:47]
    s_add_u32 s35, s35, 4
    v_mfma_f32_16x16x32_bf16 v[16:19], v[176:179], v[184:187], v[16:19]
    s_cmp_lt_u32 s35, 24
    v_mfma_f32_16x16x32_bf16 v[32:35], v[176:179], v[188:191], v[32:35]
    v_mfma_f32_16x16x32_bf16 v[48:51], v[176:179], v[192:195], v[48:51]
    v_mfma_f32_16x16x32_bf16 v[56:59], v[168:171], v[196:199], v[56:59]
    v_mfma_f32_16x16x32_bf16 v[60:63], v[172:175], v[196:199], v[60:63]
    v_mfma_f32_16x16x32_bf16 v[64:67], v[176:179], v[196:199], v[64:67]
    v_mfma_f32_16x16x32_bf16 v[20:23], v[180:183], v[184:187], v[20:23]
    v_mfma_f32_16x16x32_bf16 v[36:39], v[180:183], v[188:191], v[36:39]
    v_mfma_f32_16x16x32_bf16 v[52:55], v[180:183], v[192:195], v[52:55]
    v_mfma_f32_16x16x32_bf16 v[68:71], v[180:183], v[196:199], v[68:71]
    s_cbranch_scc1 L_g2_cloop
    s_waitcnt lgkmcnt(0)
    s_barrier
    v_mfma_f32_16x16x32_bf16 v[8:11], v[72:75], v[88:91], v[8:11]
    ds_read_b64_tr_b16 v[136:137], v208 offset:32768
    ds_read_b64_tr_b16 v[138:139], v208 offset:36864
    v_mfma_f32_16x16x32_bf16 v[24:27], v[72:75], v[92:95], v[24:27]
    ds_read_b64_tr_b16 v[152:153], v212 offset:32768
    v_mfma_f32_16x16x32_bf16 v[12:15], v[76:79], v[88:91], v[12:15]
    ds_read_b64_tr_b16 v[154:155], v212 offset:36864
    ds_read_b64_tr_b16 v[140:141], v209 offset:32768
    v_mfma_f32_16x16x32_bf16 v[28:31], v[76:79], v[92:95], v[28:31]
    ds_read_b64_tr_b16 v[142:143], v209 offset:36864
    v_mfma_f32_16x16x32_bf16 v[40:43], v[72:75], v[96:99], v[40:43]
    ds_read_b64_tr_b16 v[156:157], v213 offset:32768
    ds_read_b64_tr_b16 v[158:159], v213 offset:36864
    v_mfma_f32_16x16x32_bf16 v[44:47], v[76:79], v[96:99], v[44:47]
    ds_read_b64_tr_b16 v[144:145], v210 offset:32768
    v_mfma_f32_16x16x32_bf16 v[16:19], v[80:83], v[88:91], v[16:19]
    ds_read_b64_tr_b16 v[146:147], v210 offset:36864
    ds_read_b64_tr_b16 v[160:161], v214 offset:32768
    v_mfma_f32_16x16x32_bf16 v[32:35], v[80:83], v[92:95], v[32:35]
    ds_read_b64_tr_b16 v[162:163], v214 offset:36864
    v_mfma_f32_16x16x32_bf16 v[48:51], v[80:83], v[96:99], v[48:51]
    ds_read_b64_tr_b16 v[148:149], v211 offset:32768
    ds_read_b64_tr_b16 v[150:151], v211 offset:36864
    v_mfma_f32_16x16x32_bf16 v[56:59], v[72:75], v[100:103], v[56:59]
    ds_read_b64_tr_b16 v[164:165], v215 offset:32768
    v_mfma_f32_16x16x32_bf16 v[60:63], v[76:79], v[100:103], v[60:63]
    ds_read_b64_tr_b16 v[166:167], v215 offset:36864
    ds_read_b64_tr_b16 v[168:169], v208 offset:40960
    v_mfma_f32_16x16x32_bf16 v[64:67], v[80:83], v[100:103], v[64:67]
    ds_read_b64_tr_b16 v[170:171], v208 offset:45056
    v_mfma_f32_16x16x32_bf16 v[20:23], v[84:87], v[88:91], v[20:23]
    ds_read_b64_tr_b16 v[184:185], v212 offset:40960
    ds_read_b64_tr_b16 v[186:187], v212 offset:45056
    v_mfma_f32_16x16x32_bf16 v[36:39], v[84:87], v[92:95], v[36:39]
    ds_read_b64_tr_b16 v[172:173], v209 offset:40960
    v_mfma_f32_16x16x32_bf16 v[52:55], v[84:87], v[96:99], v[52:55]
    ds_read_b64_tr_b16 v[174:175], v209 offset:45056
    ds_read_b64_tr_b16 v[188:189], v213 offset:40960
    v_mfma_f32_16x16x32_bf16 v[68:71], v[84:87], v[100:103], v[68:71]
    ds_read_b64_tr_b16 v[190:191], v213 offset:45056
    v_mfma_f32_16x16x32_bf16 v[8:11], v[104:107], v[120:123], v[8:11]
    ds_read_b64_tr_b16 v[176:177], v210 offset:40960
    ds_read_b64_tr_b16 v[178:179], v210 offset:45056
    v_mfma_f32_16x16x32_bf16 v[24:27], v[104:107], v[124:127], v[24:27]
    ds_read_b64_tr_b16 v[192:193], v214 offset:40960
    v_mfma_f32_16x16x32_bf16 v[12:15], v[108:111], v[120:123], v[12:15]
    ds_read_b64_tr_b16 v[194:195], v214 offset:45056
    ds_read_b64_tr_b16 v[180:181], v211 offset:40960
    v_mfma_f32_16x16x32_bf16 v[28:31], v[108:111], v[124:127], v[28:31]
    ds_read_b64_tr_b16 v[182:183], v211 offset:45056
    v_mfma_f32_16x16x32_bf16 v[40:43], v[104:107], v[128:131], v[40:43]
    ds_read_b64_tr_b16 v[196:197], v215 offset:40960
    ds_read_b64_tr_b16 v[198:199], v215 offset:45056
    v_mfma_f32_16x16x32_bf16 v[44:47], v[108:111], v[128:131], v[44:47]
    v_mfma_f32_16x16x32_bf16 v[16:19], v[112:115], v[120:123], v[16:19]
    v_mfma_f32_16x16x32_bf16 v[32:35], v[112:115], v[124:127], v[32:35]
    v_mfma_f32_16x16x32_bf16 v[48:51], v[112:115], v[128:131], v[48:51]
    v_mfma_f32_16x16x32_bf16 v[56:59], v[104:107], v[132:135], v[56:59]
    v_mfma_f32_16x16x32_bf16 v[60:63], v[108:111], v[132:135], v[60:63]
    v_mfma_f32_16x16x32_bf16 v[64:67], v[112:115], v[132:135], v[64:67]
    v_mfma_f32_16x16x32_bf16 v[20:23], v[116:119], v[120:123], v[20:23]
    v_mfma_f32_16x16x32_bf16 v[36:39], v[116:119], v[124:127], v[36:39]
    v_mfma_f32_16x16x32_bf16 v[52:55], v[116:119], v[128:131], v[52:55]
    v_mfma_f32_16x16x32_bf16 v[68:71], v[116:119], v[132:135], v[68:71]
    s_waitcnt lgkmcnt(0)
    s_barrier
    v_mfma_f32_16x16x32_bf16 v[8:11], v[136:139], v[152:155], v[8:11]
    ds_read_b64_tr_b16 v[72:73], v200 offset:0
    ds_read_b64_tr_b16 v[74:75], v200 offset:4096
    v_mfma_f32_16x16x32_bf16 v[24:27], v[136:139], v[156:159], v[24:27]
    ds_read_b64_tr_b16 v[88:89], v204 offset:0
    v_mfma_f32_16x16x32_bf16 v[12:15], v[140:143], v[152:155], v[12:15]
    ds_read_b64_tr_b16 v[90:91], v204 offset:4096
    ds_read_b64_tr_b16 v[76:77], v201 offset:0
    v_mfma_f32_16x16x32_bf16 v[28:31], v[140:143], v[156:159], v[28:31]
    ds_read_b64_tr_b16 v[78:79], v201 offset:4096
    v_mfma_f32_16x16x32_bf16 v[40:43], v[136:139], v[160:163], v[40:43]
    ds_read_b64_tr_b16 v[92:93], v205 offset:0
    ds_read_b64_tr_b16 v[94:95], v205 offset:4096
    v_mfma_f32_16x16x32_bf16 v[44:47], v[140:143], v[160:163], v[44:47]
    ds_read_b64_tr_b16 v[80:81], v202 offset:0
    v_mfma_f32_16x16x32_bf16 v[16:19], v[144:147], v[152:155], v[16:19]
    ds_read_b64_tr_b16 v[82:83], v202 offset:4096
    ds_read_b64_tr_b16 v[96:97], v206 offset:0
    v_mfma_f32_16x16x32_bf16 v[32:35], v[144:147], v[156:159], v[32:35]
    ds_read_b64_tr_b16 v[98:99], v206 offset:4096
    v_mfma_f32_16x16x32_bf16 v[48:51], v[144:147], v[160:163], v[48:51]
    ds_read_b64_tr_b16 v[84:85], v203 offset:0
    ds_read_b64_tr_b16 v[86:87], v203 offset:4096
    v_mfma_f32_16x16x32_bf16 v[56:59], v[136:139], v[164:167], v[56:59]
    ds_read_b64_tr_b16 v[100:101], v207 offset:0
    v_mfma_f32_16x16x32_bf16 v[60:63], v[140:143], v[164:167], v[60:63]
    ds_read_b64_tr_b16 v[102:103], v207 offset:4096
    ds_read_b64_tr_b16 v[104:105], v200 offset:8192
    v_mfma_f32_16x16x32_bf16 v[64:67], v[144:147], v[164:167], v[64:67]
    ds_read_b64_tr_b16 v[106:107], v200 offset:12288
    v_mfma_f32_16x16x32_bf16 v[20:23], v[148:151], v[152:155], v[20:23]
    ds_read_b64_tr_b16 v[120:121], v204 offset:8192
    ds_read_b64_tr_b16 v[122:123], v204 offset:12288
    v_mfma_f32_16x16x32_bf16 v[36:39], v[148:151], v[156:159], v[36:39]
    ds_read_b64_tr_b16 v[108:109], v201 offset:8192
    v_mfma_f32_16x16x32_bf16 v[52:55], v[148:151], v[160:163], v[52:55]
    ds_read_b64_tr_b16 v[110:111], v201 offset:12288
    ds_read_b64_tr_b16 v[124:125], v205 offset:8192
    v_mfma_f32_16x16x32_bf16 v[68:71], v[148:151], v[164:167], v[68:71]
    ds_read_b64_tr_b16 v[126:127], v205 offset:12288
    v_mfma_f32_16x16x32_bf16 v[8:11], v[168:171], v[184:187], v[8:11]
    ds_read_b64_tr_b16 v[112:113], v202 offset:8192
    ds_read_b64_tr_b16 v[114:115], v202 offset:12288
    v_mfma_f32_16x16x32_bf16 v[24:27], v[168:171], v[188:191], v[24:27]
    ds_read_b64_tr_b16 v[128:129], v206 offset:8192
    v_mfma_f32_16x16x32_bf16 v[12:15], v[172:175], v[184:187], v[12:15]
    ds_read_b64_tr_b16 v[130:131], v206 offset:12288
    ds_read_b64_tr_b16 v[116:117], v203 offset:8192
    v_mfma_f32_16x16x32_bf16 v[28:31], v[172:175], v[188:191], v[28:31]
    ds_read_b64_tr_b16 v[118:119], v203 offset:12288
    v_mfma_f32_16x16x32_bf16 v[40:43], v[168:171], v[192:195], v[40:43]
    ds_read_b64_tr_b16 v[132:133], v207 offset:8192
    ds_read_b64_tr_b16 v[134:135], v207 offset:12288
    v_mfma_f32_16x16x32_bf16 v[44:47], v[172:175], v[192:195], v[44:47]
    v_mfma_f32_16x16x32_bf16 v[16:19], v[176:179], v[184:187], v[16:19]
    v_mfma_f32_16x16x32_bf16 v[32:35], v[176:179], v[188:191], v[32:35]
    v_mfma_f32_16x16x32_bf16 v[48:51], v[176:179], v[192:195], v[48:51]
    v_mfma_f32_16x16x32_bf16 v[56:59], v[168:171], v[196:199], v[56:59]
    v_mfma_f32_16x16x32_bf16 v[60:63], v[172:175], v[196:199], v[60:63]
    v_mfma_f32_16x16x32_bf16 v[64:67], v[176:179], v[196:199], v[64:67]
    v_mfma_f32_16x16x32_bf16 v[20:23], v[180:183], v[184:187], v[20:23]
    v_mfma_f32_16x16x32_bf16 v[36:39], v[180:183], v[188:191], v[36:39]
    v_mfma_f32_16x16x32_bf16 v[52:55], v[180:183], v[192:195], v[52:55]
    v_mfma_f32_16x16x32_bf16 v[68:71], v[180:183], v[196:199], v[68:71]
    s_add_u32 s56, s26, 0x2820000
    s_addc_u32 s57, s27, 0
    s_mov_b32 s58, 0x9000
    s_mov_b32 s59, 0x20000
    s_lshr_b32 s39, s2, 3
    s_add_u32 s39, s39, 256
    s_lshl_b32 s60, s39, 7
    v_mov_b32 v4, 0
    buffer_load_dword v3, v4, s[56:59], s60 offen sc0 sc1
    s_lshl_b32 s39, s62, 16
    s_add_u32 s39, s39, s38
    s_add_u32 s40, s39, 0
    buffer_load_dwordx4 v[222:225], v220, s[16:19], s40 offen
    s_add_u32 s40, s39, 64
    buffer_load_dwordx4 v[226:229], v220, s[16:19], s40 offen
    s_add_u32 s40, s39, 32768
    buffer_load_dwordx4 v[230:233], v220, s[16:19], s40 offen
    s_add_u32 s40, s39, 32832
    buffer_load_dwordx4 v[234:237], v220, s[16:19], s40 offen
    s_waitcnt lgkmcnt(0)
    s_barrier
    v_mfma_f32_16x16x32_bf16 v[8:11], v[72:75], v[88:91], v[8:11]
    ds_read_b64_tr_b16 v[136:137], v200 offset:32768
    ds_read_b64_tr_b16 v[138:139], v200 offset:36864
    v_mfma_f32_16x16x32_bf16 v[24:27], v[72:75], v[92:95], v[24:27]
    ds_read_b64_tr_b16 v[152:153], v204 offset:32768
    v_mfma_f32_16x16x32_bf16 v[12:15], v[76:79], v[88:91], v[12:15]
    ds_read_b64_tr_b16 v[154:155], v204 offset:36864
    ds_read_b64_tr_b16 v[140:141], v201 offset:32768
    v_mfma_f32_16x16x32_bf16 v[28:31], v[76:79], v[92:95], v[28:31]
    ds_read_b64_tr_b16 v[142:143], v201 offset:36864
    v_mfma_f32_16x16x32_bf16 v[40:43], v[72:75], v[96:99], v[40:43]
    ds_read_b64_tr_b16 v[156:157], v205 offset:32768
    ds_read_b64_tr_b16 v[158:159], v205 offset:36864
    v_mfma_f32_16x16x32_bf16 v[44:47], v[76:79], v[96:99], v[44:47]
    ds_read_b64_tr_b16 v[144:145], v202 offset:32768
    v_mfma_f32_16x16x32_bf16 v[16:19], v[80:83], v[88:91], v[16:19]
    ds_read_b64_tr_b16 v[146:147], v202 offset:36864
    ds_read_b64_tr_b16 v[160:161], v206 offset:32768
    v_mfma_f32_16x16x32_bf16 v[32:35], v[80:83], v[92:95], v[32:35]
    ds_read_b64_tr_b16 v[162:163], v206 offset:36864
    v_mfma_f32_16x16x32_bf16 v[48:51], v[80:83], v[96:99], v[48:51]
    ds_read_b64_tr_b16 v[148:149], v203 offset:32768
    ds_read_b64_tr_b16 v[150:151], v203 offset:36864
    v_mfma_f32_16x16x32_bf16 v[56:59], v[72:75], v[100:103], v[56:59]
    ds_read_b64_tr_b16 v[164:165], v207 offset:32768
    v_mfma_f32_16x16x32_bf16 v[60:63], v[76:79], v[100:103], v[60:63]
    ds_read_b64_tr_b16 v[166:167], v207 offset:36864
    ds_read_b64_tr_b16 v[168:169], v200 offset:40960
    v_mfma_f32_16x16x32_bf16 v[64:67], v[80:83], v[100:103], v[64:67]
    ds_read_b64_tr_b16 v[170:171], v200 offset:45056
    v_mfma_f32_16x16x32_bf16 v[20:23], v[84:87], v[88:91], v[20:23]
    ds_read_b64_tr_b16 v[184:185], v204 offset:40960
    ds_read_b64_tr_b16 v[186:187], v204 offset:45056
    v_mfma_f32_16x16x32_bf16 v[36:39], v[84:87], v[92:95], v[36:39]
    ds_read_b64_tr_b16 v[172:173], v201 offset:40960
    v_mfma_f32_16x16x32_bf16 v[52:55], v[84:87], v[96:99], v[52:55]
    ds_read_b64_tr_b16 v[174:175], v201 offset:45056
    ds_read_b64_tr_b16 v[188:189], v205 offset:40960
    v_mfma_f32_16x16x32_bf16 v[68:71], v[84:87], v[100:103], v[68:71]
    ds_read_b64_tr_b16 v[190:191], v205 offset:45056
    v_mfma_f32_16x16x32_bf16 v[8:11], v[104:107], v[120:123], v[8:11]
    ds_read_b64_tr_b16 v[176:177], v202 offset:40960
    ds_read_b64_tr_b16 v[178:179], v202 offset:45056
    v_mfma_f32_16x16x32_bf16 v[24:27], v[104:107], v[124:127], v[24:27]
    ds_read_b64_tr_b16 v[192:193], v206 offset:40960
    v_mfma_f32_16x16x32_bf16 v[12:15], v[108:111], v[120:123], v[12:15]
    ds_read_b64_tr_b16 v[194:195], v206 offset:45056
    ds_read_b64_tr_b16 v[180:181], v203 offset:40960
    v_mfma_f32_16x16x32_bf16 v[28:31], v[108:111], v[124:127], v[28:31]
    ds_read_b64_tr_b16 v[182:183], v203 offset:45056
    v_mfma_f32_16x16x32_bf16 v[40:43], v[104:107], v[128:131], v[40:43]
    ds_read_b64_tr_b16 v[196:197], v207 offset:40960
    ds_read_b64_tr_b16 v[198:199], v207 offset:45056
    v_mfma_f32_16x16x32_bf16 v[44:47], v[108:111], v[128:131], v[44:47]
    v_mfma_f32_16x16x32_bf16 v[16:19], v[112:115], v[120:123], v[16:19]
    v_mfma_f32_16x16x32_bf16 v[32:35], v[112:115], v[124:127], v[32:35]
    v_mfma_f32_16x16x32_bf16 v[48:51], v[112:115], v[128:131], v[48:51]
    v_mfma_f32_16x16x32_bf16 v[56:59], v[104:107], v[132:135], v[56:59]
    v_mfma_f32_16x16x32_bf16 v[60:63], v[108:111], v[132:135], v[60:63]
    v_mfma_f32_16x16x32_bf16 v[64:67], v[112:115], v[132:135], v[64:67]
    v_mfma_f32_16x16x32_bf16 v[20:23], v[116:119], v[120:123], v[20:23]
    v_mfma_f32_16x16x32_bf16 v[36:39], v[116:119], v[124:127], v[36:39]
    v_mfma_f32_16x16x32_bf16 v[52:55], v[116:119], v[128:131], v[52:55]
    v_mfma_f32_16x16x32_bf16 v[68:71], v[116:119], v[132:135], v[68:71]
    s_waitcnt lgkmcnt(0)
    v_mfma_f32_16x16x32_bf16 v[8:11], v[136:139], v[152:155], v[8:11]
    v_mfma_f32_16x16x32_bf16 v[24:27], v[136:139], v[156:159], v[24:27]
    v_mfma_f32_16x16x32_bf16 v[12:15], v[140:143], v[152:155], v[12:15]
    v_mfma_f32_16x16x32_bf16 v[28:31], v[140:143], v[156:159], v[28:31]
    v_mfma_f32_16x16x32_bf16 v[40:43], v[136:139], v[160:163], v[40:43]
    v_mfma_f32_16x16x32_bf16 v[44:47], v[140:143], v[160:163], v[44:47]
    v_mfma_f32_16x16x32_bf16 v[16:19], v[144:147], v[152:155], v[16:19]
    v_mfma_f32_16x16x32_bf16 v[32:35], v[144:147], v[156:159], v[32:35]
    v_mfma_f32_16x16x32_bf16 v[48:51], v[144:147], v[160:163], v[48:51]
    v_mfma_f32_16x16x32_bf16 v[56:59], v[136:139], v[164:167], v[56:59]
    v_mfma_f32_16x16x32_bf16 v[60:63], v[140:143], v[164:167], v[60:63]
    v_mfma_f32_16x16x32_bf16 v[64:67], v[144:147], v[164:167], v[64:67]
    v_mfma_f32_16x16x32_bf16 v[20:23], v[148:151], v[152:155], v[20:23]
    v_mfma_f32_16x16x32_bf16 v[36:39], v[148:151], v[156:159], v[36:39]
    v_mfma_f32_16x16x32_bf16 v[52:55], v[148:151], v[160:163], v[52:55]
    v_mfma_f32_16x16x32_bf16 v[68:71], v[148:151], v[164:167], v[68:71]
    v_mfma_f32_16x16x32_bf16 v[8:11], v[168:171], v[184:187], v[8:11]
    v_mfma_f32_16x16x32_bf16 v[24:27], v[168:171], v[188:191], v[24:27]
    v_mfma_f32_16x16x32_bf16 v[12:15], v[172:175], v[184:187], v[12:15]
    v_mfma_f32_16x16x32_bf16 v[28:31], v[172:175], v[188:191], v[28:31]
    v_mfma_f32_16x16x32_bf16 v[40:43], v[168:171], v[192:195], v[40:43]
    v_mfma_f32_16x16x32_bf16 v[44:47], v[172:175], v[192:195], v[44:47]
    v_mfma_f32_16x16x32_bf16 v[16:19], v[176:179], v[184:187], v[16:19]
    v_mfma_f32_16x16x32_bf16 v[32:35], v[176:179], v[188:191], v[32:35]
    v_mfma_f32_16x16x32_bf16 v[48:51], v[176:179], v[192:195], v[48:51]
    v_mfma_f32_16x16x32_bf16 v[56:59], v[168:171], v[196:199], v[56:59]
    v_mfma_f32_16x16x32_bf16 v[60:63], v[172:175], v[196:199], v[60:63]
    v_mfma_f32_16x16x32_bf16 v[64:67], v[176:179], v[196:199], v[64:67]
    v_mfma_f32_16x16x32_bf16 v[20:23], v[180:183], v[184:187], v[20:23]
    v_mfma_f32_16x16x32_bf16 v[36:39], v[180:183], v[188:191], v[36:39]
    v_mfma_f32_16x16x32_bf16 v[52:55], v[180:183], v[192:195], v[52:55]
    v_mfma_f32_16x16x32_bf16 v[68:71], v[180:183], v[196:199], v[68:71]
    s_mov_b32 s40, 0xffff0000
    s_waitcnt vmcnt(0)
    s_add_u32 s44, s26, 0x1e00000
    s_addc_u32 s45, s27, 0
    s_mov_b32 s46, 0x400000
    s_mov_b32 s47, 0x20000
    s_xor_b32 s42, s2, 4
    s_lshl_b32 s43, s42, 14
    s_lshl_b32 s39, s28, 12
    s_add_u32 s43, s43, s39
    v_lshlrev_b32 v2, 4, v1
    v_mov_b32 v4, 0
    s_mov_b32 s41, 0
L_g2_ffp:
    v_readfirstlane_b32 s61, v3
    s_add_u32 s41, s41, 1
    s_cmp_ge_u32 s41, 0x20000
    s_cbranch_scc1 L_g2_ffd
    s_cmp_lg_u32 s61, 0
    s_cbranch_scc1 L_g2_ffd
    buffer_load_dword v3, v4, s[56:59], s60 offen sc0 sc1
    s_waitcnt vmcnt(0)
    s_branch L_g2_ffp
L_g2_ffd:
    s_cmp_eq_u32 s62, 0
    s_cbranch_scc1 L_g2_k0s
    v_cvt_pk_bf16_f32 v168, v8, v9
    v_cvt_pk_bf16_f32 v169, v10, v11
    v_cvt_pk_bf16_f32 v170, v12, v13
    v_cvt_pk_bf16_f32 v171, v14, v15
    v_cvt_pk_bf16_f32 v172, v16, v17
    v_cvt_pk_bf16_f32 v173, v18, v19
    v_cvt_pk_bf16_f32 v174, v20, v21
    v_cvt_pk_bf16_f32 v175, v22, v23
    v_cvt_pk_bf16_f32 v176, v24, v25
    v_cvt_pk_bf16_f32 v177, v26, v27
    v_cvt_pk_bf16_f32 v178, v28, v29
    v_cvt_pk_bf16_f32 v179, v30, v31
    v_cvt_pk_bf16_f32 v180, v32, v33
    v_cvt_pk_bf16_f32 v181, v34, v35
    v_cvt_pk_bf16_f32 v182, v36, v37
    v_cvt_pk_bf16_f32 v183, v38, v39
    s_add_u32 s39, s43, 0
    buffer_store_dwordx4 v[168:171], v2, s[44:47], s39 offen sc0 sc1
    s_add_u32 s39, s43, 1024
    buffer_store_dwordx4 v[172:175], v2, s[44:47], s39 offen sc0 sc1
    s_add_u32 s39, s43, 2048
    buffer_store_dwordx4 v[176:179], v2, s[44:47], s39 offen sc0 sc1
    s_add_u32 s39, s43, 3072
    buffer_store_dwordx4 v[180:183], v2, s[44:47], s39 offen sc0 sc1
    s_branch L_g2_k1s
L_g2_k0s:
    v_cvt_pk_bf16_f32 v168, v40, v41
    v_cvt_pk_bf16_f32 v169, v42, v43
    v_cvt_pk_bf16_f32 v170, v44, v45
    v_cvt_pk_bf16_f32 v171, v46, v47
    v_cvt_pk_bf16_f32 v172, v48, v49
    v_cvt_pk_bf16_f32 v173, v50, v51
    v_cvt_pk_bf16_f32 v174, v52, v53
    v_cvt_pk_bf16_f32 v175, v54, v55
    v_cvt_pk_bf16_f32 v176, v56, v57
    v_cvt_pk_bf16_f32 v177, v58, v59
    v_cvt_pk_bf16_f32 v178, v60, v61
    v_cvt_pk_bf16_f32 v179, v62, v63
    v_cvt_pk_bf16_f32 v180, v64, v65
    v_cvt_pk_bf16_f32 v181, v66, v67
    v_cvt_pk_bf16_f32 v182, v68, v69
    v_cvt_pk_bf16_f32 v183, v70, v71
    s_add_u32 s39, s43, 0
    buffer_store_dwordx4 v[168:171], v2, s[44:47], s39 offen sc0 sc1
    s_add_u32 s39, s43, 1024
    buffer_store_dwordx4 v[172:175], v2, s[44:47], s39 offen sc0 sc1
    s_add_u32 s39, s43, 2048
    buffer_store_dwordx4 v[176:179], v2, s[44:47], s39 offen sc0 sc1
    s_add_u32 s39, s43, 3072
    buffer_store_dwordx4 v[180:183], v2, s[44:47], s39 offen sc0 sc1
L_g2_k1s:
    s_lshl_b32 s43, s2, 14
    s_lshl_b32 s39, s28, 12
    s_add_u32 s43, s43, s39
    s_mov_b32 s41, 0
    s_waitcnt vmcnt(0)
L_g2_spoll:
    s_add_u32 s39, s43, 0
    buffer_load_dwordx4 v[168:171], v2, s[44:47], s39 offen sc0 sc1
    s_add_u32 s39, s43, 1024
    buffer_load_dwordx4 v[172:175], v2, s[44:47], s39 offen sc0 sc1
    s_add_u32 s39, s43, 2048
    buffer_load_dwordx4 v[176:179], v2, s[44:47], s39 offen sc0 sc1
    s_add_u32 s39, s43, 3072
    buffer_load_dwordx4 v[180:183], v2, s[44:47], s39 offen sc0 sc1
    s_add_u32 s41, s41, 1
    s_waitcnt vmcnt(0)
    v_max3_u32 v3, v168, v169, v170
    v_max3_u32 v3, v3, v171, v172
    v_max3_u32 v3, v3, v173, v174
    v_max3_u32 v3, v3, v175, v176
    v_max3_u32 v3, v3, v177, v178
    v_max3_u32 v3, v3, v179, v180
    v_max3_u32 v3, v3, v181, v182
    v_max_u32 v3, v3, v183
    v_cmp_eq_u32 vcc, -1, v3
    s_nop 4
    s_cmp_ge_u32 s41, 0x20000
    s_cbranch_scc1 L_g2_spolld
    s_cbranch_vccnz L_g2_spoll
L_g2_spolld:
    s_cmp_eq_u32 s62, 0
    s_cbranch_scc1 L_g2_kept
    v_mov_b32 v8, v40
    v_mov_b32 v9, v41
    v_mov_b32 v10, v42
    v_mov_b32 v11, v43
    v_mov_b32 v12, v44
    v_mov_b32 v13, v45
    v_mov_b32 v14, v46
    v_mov_b32 v15, v47
    v_mov_b32 v16, v48
    v_mov_b32 v17, v49
    v_mov_b32 v18, v50
    v_mov_b32 v19, v51
    v_mov_b32 v20, v52
    v_mov_b32 v21, v53
    v_mov_b32 v22, v54
    v_mov_b32 v23, v55
    v_mov_b32 v24, v56
    v_mov_b32 v25, v57
    v_mov_b32 v26, v58
    v_mov_b32 v27, v59
    v_mov_b32 v28, v60
    v_mov_b32 v29, v61
    v_mov_b32 v30, v62
    v_mov_b32 v31, v63
    v_mov_b32 v32, v64
    v_mov_b32 v33, v65
    v_mov_b32 v34, v66
    v_mov_b32 v35, v67
    v_mov_b32 v36, v68
    v_mov_b32 v37, v69
    v_mov_b32 v38, v70
    v_mov_b32 v39, v71
    v_mov_b32 v216, v218
    v_mov_b32 v217, v219
L_g2_kept:
    v_lshlrev_b32 v216, 16, v216
    v_lshlrev_b32 v217, 16, v217
    s_lshl_b32 s39, s62, 16
    s_add_u32 s38, s38, s39
    v_and_b32 v2, 7, v1
    v_lshlrev_b32 v2, 11, v2
    v_bfe_u32 v3, v1, 3, 1
    v_lshl_add_u32 v2, v3, 6, v2
    v_lshrrev_b32 v3, 4, v1
    v_lshl_add_u32 v3, v3, 4, v2
    v_lshlrev_b32 v136, 16, v168
    v_and_b32 v137, s40, v168
    v_pk_add_f32 v[8:9], v[8:9], v[136:137]
    v_add_f32 v80, v8, v216
    v_add_f32 v81, v9, v216
    v_cvt_pk_bf16_f32 v72, v80, v81
    v_lshlrev_b32 v138, 16, v169
    v_and_b32 v139, s40, v169
    v_pk_add_f32 v[10:11], v[10:11], v[138:139]
    v_add_f32 v84, v10, v216
    v_add_f32 v85, v11, v216
    v_cvt_pk_bf16_f32 v73, v84, v85
    v_lshlrev_b32 v140, 16, v170
    v_and_b32 v141, s40, v170
    v_pk_add_f32 v[12:13], v[12:13], v[140:141]
    v_add_f32 v88, v12, v216
    v_add_f32 v89, v13, v216
    v_cvt_pk_bf16_f32 v74, v88, v89
    v_lshlrev_b32 v142, 16, v171
    v_and_b32 v143, s40, v171
    v_pk_add_f32 v[14:15], v[14:15], v[142:143]
    v_add_f32 v92, v14, v216
    v_add_f32 v93, v15, v216
    v_cvt_pk_bf16_f32 v75, v92, v93
    v_permlane32_swap_b32 v72, v74
    s_nop 0
    v_permlane32_swap_b32 v73, v75
    v_permlane16_swap_b32 v72, v74
    s_nop 0
    v_permlane16_swap_b32 v73, v75
    v_lshlrev_b32 v80, 16, v72
    v_and_b32 v81, s40, v72
    v_lshlrev_b32 v82, 16, v222
    v_and_b32 v83, s40, v222
    v_pk_add_f32 v[80:81], v[80:81], v[82:83]
    v_cvt_pk_bf16_f32 v72, v80, v81
    v_lshlrev_b32 v84, 16, v73
    v_and_b32 v85, s40, v73
    v_lshlrev_b32 v86, 16, v223
    v_and_b32 v87, s40, v223
    v_pk_add_f32 v[84:85], v[84:85], v[86:87]
    v_cvt_pk_bf16_f32 v73, v84, v85
    v_lshlrev_b32 v88, 16, v74
    v_and_b32 v89, s40, v74
    v_lshlrev_b32 v90, 16, v224
    v_and_b32 v91, s40, v224
    v_pk_add_f32 v[88:89], v[88:89], v[90:91]
    v_cvt_pk_bf16_f32 v74, v88, v89
    v_lshlrev_b32 v92, 16, v75
    v_and_b32 v93, s40, v75
    v_lshlrev_b32 v94, 16, v225
    v_and_b32 v95, s40, v225
    v_pk_add_f32 v[92:93], v[92:93], v[94:95]
    v_cvt_pk_bf16_f32 v75, v92, v93
    v_lshlrev_b32 v144, 16, v172
    v_and_b32 v145, s40, v172
    v_pk_add_f32 v[16:17], v[16:17], v[144:145]
    v_add_f32 v80, v16, v216
    v_add_f32 v81, v17, v216
    v_cvt_pk_bf16_f32 v76, v80, v81
    v_lshlrev_b32 v146, 16, v173
    v_and_b32 v147, s40, v173
    v_pk_add_f32 v[18:19], v[18:19], v[146:147]
    v_add_f32 v84, v18, v216
    v_add_f32 v85, v19, v216
    v_cvt_pk_bf16_f32 v77, v84, v85
    v_lshlrev_b32 v148, 16, v174
    v_and_b32 v149, s40, v174
    v_pk_add_f32 v[20:21], v[20:21], v[148:149]
    v_add_f32 v88, v20, v216
    v_add_f32 v89, v21, v216
    v_cvt_pk_bf16_f32 v78, v88, v89
    v_lshlrev_b32 v150, 16, v175
    v_and_b32 v151, s40, v175
    v_pk_add_f32 v[22:23], v[22:23], v[150:151]
    v_add_f32 v92, v22, v216
    v_add_f32 v93, v23, v216
    v_cvt_pk_bf16_f32 v79, v92, v93
    v_permlane32_swap_b32 v76, v78
    s_nop 0
    v_permlane32_swap_b32 v77, v79
    v_permlane16_swap_b32 v76, v78
    s_nop 0
    v_permlane16_swap_b32 v77, v79
    v_lshlrev_b32 v80, 16, v76
    v_and_b32 v81, s40, v76
    v_lshlrev_b32 v82, 16, v226
    v_and_b32 v83, s40, v226
    v_pk_add_f32 v[80:81], v[80:81], v[82:83]
    v_cvt_pk_bf16_f32 v76, v80, v81
    v_lshlrev_b32 v84, 16, v77
    v_and_b32 v85, s40, v77
    v_lshlrev_b32 v86, 16, v227
    v_and_b32 v87, s40, v227
    v_pk_add_f32 v[84:85], v[84:85], v[86:87]
    v_cvt_pk_bf16_f32 v77, v84, v85
    v_lshlrev_b32 v88, 16, v78
    v_and_b32 v89, s40, v78
    v_lshlrev_b32 v90, 16, v228
    v_and_b32 v91, s40, v228
    v_pk_add_f32 v[88:89], v[88:89], v[90:91]
    v_cvt_pk_bf16_f32 v78, v88, v89
    v_lshlrev_b32 v92, 16, v79
    v_and_b32 v93, s40, v79
    v_lshlrev_b32 v94, 16, v229
    v_and_b32 v95, s40, v229
    v_pk_add_f32 v[92:93], v[92:93], v[94:95]
    v_cvt_pk_bf16_f32 v79, v92, v93
    v_mov_b32 v104, v72
    v_mov_b32 v105, v73
    v_mov_b32 v106, v74
    v_mov_b32 v107, v75
    v_mov_b32_dpp v72, v76 row_ror:8 row_mask:0xf bank_mask:0xc
    v_mov_b32_dpp v73, v77 row_ror:8 row_mask:0xf bank_mask:0xc
    v_mov_b32_dpp v74, v78 row_ror:8 row_mask:0xf bank_mask:0xc
    v_mov_b32_dpp v75, v79 row_ror:8 row_mask:0xf bank_mask:0xc
    v_mov_b32_dpp v76, v104 row_ror:8 row_mask:0xf bank_mask:0x3
    v_mov_b32_dpp v77, v105 row_ror:8 row_mask:0xf bank_mask:0x3
    v_mov_b32_dpp v78, v106 row_ror:8 row_mask:0xf bank_mask:0x3
    v_mov_b32_dpp v79, v107 row_ror:8 row_mask:0xf bank_mask:0x3
    s_add_u32 s41, s38, 0
    buffer_store_dwordx4 v[72:75], v3, s[48:51], s41 offen nt
    s_add_u32 s41, s38, 16384
    buffer_store_dwordx4 v[76:79], v3, s[48:51], s41 offen nt
    v_lshlrev_b32 v152, 16, v176
    v_and_b32 v153, s40, v176
    v_pk_add_f32 v[24:25], v[24:25], v[152:153]
    v_add_f32 v80, v24, v217
    v_add_f32 v81, v25, v217
    v_cvt_pk_bf16_f32 v96, v80, v81
    v_lshlrev_b32 v154, 16, v177
    v_and_b32 v155, s40, v177
    v_pk_add_f32 v[26:27], v[26:27], v[154:155]
    v_add_f32 v84, v26, v217
    v_add_f32 v85, v27, v217
    v_cvt_pk_bf16_f32 v97, v84, v85
    v_lshlrev_b32 v156, 16, v178
    v_and_b32 v157, s40, v178
    v_pk_add_f32 v[28:29], v[28:29], v[156:157]
    v_add_f32 v88, v28, v217
    v_add_f32 v89, v29, v217
    v_cvt_pk_bf16_f32 v98, v88, v89
    v_lshlrev_b32 v158, 16, v179
    v_and_b32 v159, s40, v179
    v_pk_add_f32 v[30:31], v[30:31], v[158:159]
    v_add_f32 v92, v30, v217
    v_add_f32 v93, v31, v217
    v_cvt_pk_bf16_f32 v99, v92, v93
    v_permlane32_swap_b32 v96, v98
    s_nop 0
    v_permlane32_swap_b32 v97, v99
    v_permlane16_swap_b32 v96, v98
    s_nop 0
    v_permlane16_swap_b32 v97, v99
    v_lshlrev_b32 v80, 16, v96
    v_and_b32 v81, s40, v96
    v_lshlrev_b32 v82, 16, v230
    v_and_b32 v83, s40, v230
    v_pk_add_f32 v[80:81], v[80:81], v[82:83]
    v_cvt_pk_bf16_f32 v96, v80, v81
    v_lshlrev_b32 v84, 16, v97
    v_and_b32 v85, s40, v97
    v_lshlrev_b32 v86, 16, v231
    v_and_b32 v87, s40, v231
    v_pk_add_f32 v[84:85], v[84:85], v[86:87]
    v_cvt_pk_bf16_f32 v97, v84, v85
    v_lshlrev_b32 v88, 16, v98
    v_and_b32 v89, s40, v98
    v_lshlrev_b32 v90, 16, v232
    v_and_b32 v91, s40, v232
    v_pk_add_f32 v[88:89], v[88:89], v[90:91]
    v_cvt_pk_bf16_f32 v98, v88, v89
    v_lshlrev_b32 v92, 16, v99
    v_and_b32 v93, s40, v99
    v_lshlrev_b32 v94, 16, v233
    v_and_b32 v95, s40, v233
    v_pk_add_f32 v[92:93], v[92:93], v[94:95]
    v_cvt_pk_bf16_f32 v99, v92, v93
    v_lshlrev_b32 v160, 16, v180
    v_and_b32 v161, s40, v180
    v_pk_add_f32 v[32:33], v[32:33], v[160:161]
    v_add_f32 v80, v32, v217
    v_add_f32 v81, v33, v217
    v_cvt_pk_bf16_f32 v100, v80, v81
    v_lshlrev_b32 v162, 16, v181
    v_and_b32 v163, s40, v181
    v_pk_add_f32 v[34:35], v[34:35], v[162:163]
    v_add_f32 v84, v34, v217
    v_add_f32 v85, v35, v217
    v_cvt_pk_bf16_f32 v101, v84, v85
    v_lshlrev_b32 v164, 16, v182
    v_and_b32 v165, s40, v182
    v_pk_add_f32 v[36:37], v[36:37], v[164:165]
    v_add_f32 v88, v36, v217
    v_add_f32 v89, v37, v217
    v_cvt_pk_bf16_f32 v102, v88, v89
    v_lshlrev_b32 v166, 16, v183
    v_and_b32 v167, s40, v183
    v_pk_add_f32 v[38:39], v[38:39], v[166:167]
    v_add_f32 v92, v38, v217
    v_add_f32 v93, v39, v217
    v_cvt_pk_bf16_f32 v103, v92, v93
    v_permlane32_swap_b32 v100, v102
    s_nop 0
    v_permlane32_swap_b32 v101, v103
    v_permlane16_swap_b32 v100, v102
    s_nop 0
    v_permlane16_swap_b32 v101, v103
    v_lshlrev_b32 v80, 16, v100
    v_and_b32 v81, s40, v100
    v_lshlrev_b32 v82, 16, v234
    v_and_b32 v83, s40, v234
    v_pk_add_f32 v[80:81], v[80:81], v[82:83]
    v_cvt_pk_bf16_f32 v100, v80, v81
    v_lshlrev_b32 v84, 16, v101
    v_and_b32 v85, s40, v101
    v_lshlrev_b32 v86, 16, v235
    v_and_b32 v87, s40, v235
    v_pk_add_f32 v[84:85], v[84:85], v[86:87]
    v_cvt_pk_bf16_f32 v101, v84, v85
    v_lshlrev_b32 v88, 16, v102
    v_and_b32 v89, s40, v102
    v_lshlrev_b32 v90, 16, v236
    v_and_b32 v91, s40, v236
    v_pk_add_f32 v[88:89], v[88:89], v[90:91]
    v_cvt_pk_bf16_f32 v102, v88, v89
    v_lshlrev_b32 v92, 16, v103
    v_and_b32 v93, s40, v103
    v_lshlrev_b32 v94, 16, v237
    v_and_b32 v95, s40, v237
    v_pk_add_f32 v[92:93], v[92:93], v[94:95]
    v_cvt_pk_bf16_f32 v103, v92, v93
    v_mov_b32 v104, v96
    v_mov_b32 v105, v97
    v_mov_b32 v106, v98
    v_mov_b32 v107, v99
    v_mov_b32_dpp v96, v100 row_ror:8 row_mask:0xf bank_mask:0xc
    v_mov_b32_dpp v97, v101 row_ror:8 row_mask:0xf bank_mask:0xc
    v_mov_b32_dpp v98, v102 row_ror:8 row_mask:0xf bank_mask:0xc
    v_mov_b32_dpp v99, v103 row_ror:8 row_mask:0xf bank_mask:0xc
    v_mov_b32_dpp v100, v104 row_ror:8 row_mask:0xf bank_mask:0x3
    v_mov_b32_dpp v101, v105 row_ror:8 row_mask:0xf bank_mask:0x3
    v_mov_b32_dpp v102, v106 row_ror:8 row_mask:0xf bank_mask:0x3
    v_mov_b32_dpp v103, v107 row_ror:8 row_mask:0xf bank_mask:0x3
    s_add_u32 s41, s38, 32768
    buffer_store_dwordx4 v[96:99], v3, s[48:51], s41 offen nt
    s_add_u32 s41, s38, 49152
    buffer_store_dwordx4 v[100:103], v3, s[48:51], s41 offen nt
    s_branch L_gg_end
L_g2_prod:
    s_setprio 3
    s_sub_u32 s33, s28, 4
    v_lshrrev_b32 v2, 4, v1
    s_and_b32 s34, s33, 1
    s_lshl_b32 s34, s34, 2
    v_add_u32 v3, s34, v2
    v_lshlrev_b32 v3, 1, v3
    v_and_b32 v4, 15, v1
    v_xor_b32 v3, v3, v4
    v_lshlrev_b32 v3, 4, v3
    v_lshl_add_u32 v8, v2, 11, v3
    v_mul_u32_u24 v2, 4096, v2
    v_add_u32 v9, v2, v3
    s_lshl_b32 s34, s33, 13
    s_add_u32 s40, s32, s34
    s_mul_i32 s34, s33, 16384
    s_add_u32 s41, s31, s34
    s_lshl_b32 s42, s33, 10
    s_mov_b32 s43, 0
    s_add_u32 s46, s52, s53
    s_mov_b32 s47, 0
    s_add_u32 s36, s26, 0x2820000
    s_addc_u32 s37, s27, 0
    s_mov_b32 s38, 0x9000
    s_mov_b32 s39, 0x20000
    s_lshl_b32 s57, s30, 12
    v_mov_b32 v11, 0
    s_mov_b32 s61, 0
    s_add_u32 s56, s52, s61
    s_and_b32 s56, s56, 3
    s_cmp_lt_u32 s61, 2
    s_cselect_b32 s56, 1, s56
    s_and_b32 s59, s61, 0xfffffffe
    s_cmp_eq_u32 s59, 24
    s_cselect_b32 s59, 7, 31
    s_cmp_eq_u32 s56, 0
    s_cselect_b32 s56, s59, 27
    s_add_u32 s56, s56, s61
    s_add_u32 s56, s56, s55
    s_cmp_ge_u32 s56, 56
    s_cselect_b32 s59, 56, 28
    s_cmp_ge_u32 s56, 28
    s_cselect_b32 s59, s59, 0
    s_sub_u32 s56, s56, s59
    s_cmp_ge_u32 s56, 28
    s_cselect_b32 s59, 28, 0
    s_sub_u32 s56, s56, s59
    s_add_u32 s56, s56, s63
    s_lshr_b32 s54, s56, 1
    s_lshl_b32 s54, s54, 7
    s_add_u32 s54, s54, s57
    s_mov_b32 s61, 1
    s_add_u32 s56, s52, s61
    s_and_b32 s56, s56, 3
    s_cmp_lt_u32 s61, 2
    s_cselect_b32 s56, 1, s56
    s_and_b32 s59, s61, 0xfffffffe
    s_cmp_eq_u32 s59, 24
    s_cselect_b32 s59, 7, 31
    s_cmp_eq_u32 s56, 0
    s_cselect_b32 s56, s59, 27
    s_add_u32 s56, s56, s61
    s_add_u32 s56, s56, s55
    s_cmp_ge_u32 s56, 56
    s_cselect_b32 s59, 56, 28
    s_cmp_ge_u32 s56, 28
    s_cselect_b32 s59, s59, 0
    s_sub_u32 s56, s56, s59
    s_cmp_ge_u32 s56, 28
    s_cselect_b32 s59, 28, 0
    s_sub_u32 s56, s56, s59
    s_add_u32 s56, s56, s63
    s_lshr_b32 s35, s56, 1
    s_lshl_b32 s35, s35, 7
    s_add_u32 s35, s35, s57
    buffer_load_dword v10, v11, s[36:39], s54 offen sc0 sc1
    buffer_load_dword v12, v11, s[36:39], s35 offen sc0 sc1
    s_add_u32 s58, s52, s47
    s_and_b32 s58, s58, 3
    s_cmp_lt_u32 s47, 2
    s_cselect_b32 s58, 1, s58
    s_and_b32 s59, s47, 0xfffffffe
    s_cmp_eq_u32 s59, 24
    s_cselect_b32 s59, 7, 31
    s_cmp_eq_u32 s58, 0
    s_cselect_b32 s58, s59, 27
    s_add_u32 s58, s58, s47
    s_add_u32 s58, s58, s55
    s_cmp_ge_u32 s58, 56
    s_cselect_b32 s59, 56, 28
    s_cmp_ge_u32 s58, 28
    s_cselect_b32 s59, s59, 0
    s_sub_u32 s58, s58, s59
    s_cmp_ge_u32 s58, 28
    s_cselect_b32 s59, 28, 0
    s_sub_u32 s58, s58, s59
    s_add_u32 s58, s58, s63
    s_mul_i32 s59, s58, 262144
    s_lshl_b32 s58, s58, 17
    s_add_u32 s58, s58, s40
    s_add_u32 s59, s59, s41
    s_add_u32 s44, s43, s42
    s_add_u32 m0, s44, 16384
    s_add_u32 s45, s59, 0
    buffer_load_dwordx4 v9, s[8:11], s45 offen  lds
    s_add_u32 m0, s44, 20480
    s_add_u32 s45, s59, 65536
    buffer_load_dwordx4 v9, s[8:11], s45 offen  lds
    s_add_u32 m0, s44, 24576
    s_add_u32 s45, s59, 131072
    buffer_load_dwordx4 v9, s[8:11], s45 offen  lds
    s_add_u32 m0, s44, 28672
    s_add_u32 s45, s59, 196608
    buffer_load_dwordx4 v9, s[8:11], s45 offen  lds
    s_add_u32 s47, s47, 1
    s_add_u32 s43, s43, 32768
    s_cmp_eq_u32 s43, 131072
    s_cselect_b32 s43, 0, s43
    s_add_u32 s58, s52, s47
    s_and_b32 s58, s58, 3
    s_cmp_lt_u32 s47, 2
    s_cselect_b32 s58, 1, s58
    s_and_b32 s59, s47, 0xfffffffe
    s_cmp_eq_u32 s59, 24
    s_cselect_b32 s59, 7, 31
    s_cmp_eq_u32 s58, 0
    s_cselect_b32 s58, s59, 27
    s_add_u32 s58, s58, s47
    s_add_u32 s58, s58, s55
    s_cmp_ge_u32 s58, 56
    s_cselect_b32 s59, 56, 28
    s_cmp_ge_u32 s58, 28
    s_cselect_b32 s59, s59, 0
    s_sub_u32 s58, s58, s59
    s_cmp_ge_u32 s58, 28
    s_cselect_b32 s59, 28, 0
    s_sub_u32 s58, s58, s59
    s_add_u32 s58, s58, s63
    s_mul_i32 s59, s58, 262144
    s_lshl_b32 s58, s58, 17
    s_add_u32 s58, s58, s40
    s_add_u32 s59, s59, s41
    s_add_u32 s44, s43, s42
    s_add_u32 m0, s44, 16384
    s_add_u32 s45, s59, 0
    buffer_load_dwordx4 v9, s[8:11], s45 offen  lds
    s_add_u32 m0, s44, 20480
    s_add_u32 s45, s59, 65536
    buffer_load_dwordx4 v9, s[8:11], s45 offen  lds
    s_add_u32 m0, s44, 24576
    s_add_u32 s45, s59, 131072
    buffer_load_dwordx4 v9, s[8:11], s45 offen  lds
    s_add_u32 m0, s44, 28672
    s_add_u32 s45, s59, 196608
    buffer_load_dwordx4 v9, s[8:11], s45 offen  lds
    s_add_u32 s47, s47, 1
    s_add_u32 s43, s43, 32768
    s_cmp_eq_u32 s43, 131072
    s_cselect_b32 s43, 0, s43
    s_mov_b32 s47, 0
    s_mov_b32 s43, 0
    s_waitcnt vmcnt(10)
    s_barrier
    s_waitcnt vmcnt(8)
    s_cmp_eq_u32 s3, -1
    s_cbranch_scc1 L_g2_notown
    v_mov_b32 v10, 1
    v_mov_b32 v12, 1
L_g2_notown:
    v_readfirstlane_b32 s56, v10
    s_nop 0
    s_cmp_lg_u32 s56, 0
    s_cbranch_scc1 L_g2_ea
    s_mov_b32 s61, 0
L_g2_epa:
    s_sleep 4
    buffer_load_dword v10, v11, s[36:39], s54 offen sc0 sc1
    s_waitcnt vmcnt(0)
    v_readfirstlane_b32 s56, v10
    s_add_u32 s61, s61, 1
    s_cmp_ge_u32 s61, 0x20000
    s_cbranch_scc1 L_g2_ea
    s_cmp_eq_u32 s56, 0
    s_cbranch_scc1 L_g2_epa
L_g2_ea:
    s_mov_b32 s61, 2
    s_add_u32 s56, s52, s61
    s_and_b32 s56, s56, 3
    s_cmp_lt_u32 s61, 2
    s_cselect_b32 s56, 1, s56
    s_and_b32 s59, s61, 0xfffffffe
    s_cmp_eq_u32 s59, 24
    s_cselect_b32 s59, 7, 31
    s_cmp_eq_u32 s56, 0
    s_cselect_b32 s56, s59, 27
    s_add_u32 s56, s56, s61
    s_add_u32 s56, s56, s55
    s_cmp_ge_u32 s56, 56
    s_cselect_b32 s59, 56, 28
    s_cmp_ge_u32 s56, 28
    s_cselect_b32 s59, s59, 0
    s_sub_u32 s56, s56, s59
    s_cmp_ge_u32 s56, 28
    s_cselect_b32 s59, 28, 0
    s_sub_u32 s56, s56, s59
    s_add_u32 s56, s56, s63
    s_lshr_b32 s54, s56, 1
    s_lshl_b32 s54, s54, 7
    s_add_u32 s54, s54, s57
    buffer_load_dword v10, v11, s[36:39], s54 offen sc0 sc1
    s_add_u32 s58, s52, s47
    s_and_b32 s58, s58, 3
    s_cmp_lt_u32 s47, 2
    s_cselect_b32 s58, 1, s58
    s_and_b32 s59, s47, 0xfffffffe
    s_cmp_eq_u32 s59, 24
    s_cselect_b32 s59, 7, 31
    s_cmp_eq_u32 s58, 0
    s_cselect_b32 s58, s59, 27
    s_add_u32 s58, s58, s47
    s_add_u32 s58, s58, s55
    s_cmp_ge_u32 s58, 56
    s_cselect_b32 s59, 56, 28
    s_cmp_ge_u32 s58, 28
    s_cselect_b32 s59, s59, 0
    s_sub_u32 s58, s58, s59
    s_cmp_ge_u32 s58, 28
    s_cselect_b32 s59, 28, 0
    s_sub_u32 s58, s58, s59
    s_add_u32 s58, s58, s63
    s_mul_i32 s59, s58, 262144
    s_lshl_b32 s58, s58, 17
    s_add_u32 s58, s58, s40
    s_add_u32 s59, s59, s41
    s_add_u32 s44, s43, s42
    s_add_u32 m0, s44, 0
    s_add_u32 s45, s58, 0
    buffer_load_dwordx4 v8, s[12:15], s45 offen sc1 lds
    s_add_u32 m0, s44, 4096
    s_add_u32 s45, s58, 32768
    buffer_load_dwordx4 v8, s[12:15], s45 offen sc1 lds
    s_add_u32 m0, s44, 8192
    s_add_u32 s45, s58, 65536
    buffer_load_dwordx4 v8, s[12:15], s45 offen sc1 lds
    s_add_u32 m0, s44, 12288
    s_add_u32 s45, s58, 98304
    buffer_load_dwordx4 v8, s[12:15], s45 offen sc1 lds
    s_add_u32 s47, s47, 1
    s_add_u32 s43, s43, 32768
    s_cmp_eq_u32 s43, 131072
    s_cselect_b32 s43, 0, s43
    v_readfirstlane_b32 s56, v12
    s_nop 0
    s_cmp_lg_u32 s56, 0
    s_cbranch_scc1 L_g2_eb
    s_mov_b32 s61, 0
L_g2_epb:
    s_sleep 4
    buffer_load_dword v12, v11, s[36:39], s35 offen sc0 sc1
    s_waitcnt vmcnt(0)
    v_readfirstlane_b32 s56, v12
    s_add_u32 s61, s61, 1
    s_cmp_ge_u32 s61, 0x20000
    s_cbranch_scc1 L_g2_eb
    s_cmp_eq_u32 s56, 0
    s_cbranch_scc1 L_g2_epb
L_g2_eb:
    s_add_u32 s58, s52, s47
    s_and_b32 s58, s58, 3
    s_cmp_lt_u32 s47, 2
    s_cselect_b32 s58, 1, s58
    s_and_b32 s59, s47, 0xfffffffe
    s_cmp_eq_u32 s59, 24
    s_cselect_b32 s59, 7, 31
    s_cmp_eq_u32 s58, 0
    s_cselect_b32 s58, s59, 27
    s_add_u32 s58, s58, s47
    s_add_u32 s58, s58, s55
    s_cmp_ge_u32 s58, 56
    s_cselect_b32 s59, 56, 28
    s_cmp_ge_u32 s58, 28
    s_cselect_b32 s59, s59, 0
    s_sub_u32 s58, s58, s59
    s_cmp_ge_u32 s58, 28
    s_cselect_b32 s59, 28, 0
    s_sub_u32 s58, s58, s59
    s_add_u32 s58, s58, s63
    s_mul_i32 s59, s58, 262144
    s_lshl_b32 s58, s58, 17
    s_add_u32 s58, s58, s40
    s_add_u32 s59, s59, s41
    s_add_u32 s44, s43, s42
    s_add_u32 m0, s44, 0
    s_add_u32 s45, s58, 0
    buffer_load_dwordx4 v8, s[12:15], s45 offen sc1 lds
    s_add_u32 m0, s44, 4096
    s_add_u32 s45, s58, 32768
    buffer_load_dwordx4 v8, s[12:15], s45 offen sc1 lds
    s_add_u32 m0, s44, 8192
    s_add_u32 s45, s58, 65536
    buffer_load_dwordx4 v8, s[12:15], s45 offen sc1 lds
    s_add_u32 m0, s44, 12288
    s_add_u32 s45, s58, 98304
    buffer_load_dwordx4 v8, s[12:15], s45 offen sc1 lds
    s_add_u32 s47, s47, 1
    s_add_u32 s43, s43, 32768
    s_cmp_eq_u32 s43, 131072
    s_cselect_b32 s43, 0, s43
    s_waitcnt vmcnt(4)
    s_barrier
    v_readfirstlane_b32 s56, v10
    s_nop 0
    s_cmp_lg_u32 s56, 0
    s_cbranch_scc1 L_g2_fok4
    s_mov_b32 s61, 0
L_g2_fpoll4:
    s_sleep 4
    buffer_load_dword v10, v11, s[36:39], s54 offen sc0 sc1
    s_waitcnt vmcnt(0)
    v_readfirstlane_b32 s56, v10
    s_add_u32 s61, s61, 1
    s_cmp_ge_u32 s61, 0x20000
    s_cbranch_scc1 L_g2_fok4
    s_cmp_eq_u32 s56, 0
    s_cbranch_scc1 L_g2_fpoll4
L_g2_fok4:
    s_add_u32 s61, s47, 1
    s_add_u32 s56, s52, s61
    s_and_b32 s56, s56, 3
    s_cmp_lt_u32 s61, 2
    s_cselect_b32 s56, 1, s56
    s_and_b32 s59, s61, 0xfffffffe
    s_cmp_eq_u32 s59, 24
    s_cselect_b32 s59, 7, 31
    s_cmp_eq_u32 s56, 0
    s_cselect_b32 s56, s59, 27
    s_add_u32 s56, s56, s61
    s_add_u32 s56, s56, s55
    s_cmp_ge_u32 s56, 56
    s_cselect_b32 s59, 56, 28
    s_cmp_ge_u32 s56, 28
    s_cselect_b32 s59, s59, 0
    s_sub_u32 s56, s56, s59
    s_cmp_ge_u32 s56, 28
    s_cselect_b32 s59, 28, 0
    s_sub_u32 s56, s56, s59
    s_add_u32 s56, s56, s63
    s_lshr_b32 s54, s56, 1
    s_lshl_b32 s54, s54, 7
    s_add_u32 s54, s54, s57
    buffer_load_dword v10, v11, s[36:39], s54 offen sc0 sc1
    s_add_u32 s58, s52, s47
    s_and_b32 s58, s58, 3
    s_cmp_lt_u32 s47, 2
    s_cselect_b32 s58, 1, s58
    s_and_b32 s59, s47, 0xfffffffe
    s_cmp_eq_u32 s59, 24
    s_cselect_b32 s59, 7, 31
    s_cmp_eq_u32 s58, 0
    s_cselect_b32 s58, s59, 27
    s_add_u32 s58, s58, s47
    s_add_u32 s58, s58, s55
    s_cmp_ge_u32 s58, 56
    s_cselect_b32 s59, 56, 28
    s_cmp_ge_u32 s58, 28
    s_cselect_b32 s59, s59, 0
    s_sub_u32 s58, s58, s59
    s_cmp_ge_u32 s58, 28
    s_cselect_b32 s59, 28, 0
    s_sub_u32 s58, s58, s59
    s_add_u32 s58, s58, s63
    s_mul_i32 s59, s58, 262144
    s_lshl_b32 s58, s58, 17
    s_add_u32 s58, s58, s40
    s_add_u32 s59, s59, s41
    s_add_u32 s44, s43, s42
    s_add_u32 m0, s44, 0
    s_add_u32 s45, s58, 0
    buffer_load_dwordx4 v8, s[12:15], s45 offen sc1 lds
    s_add_u32 m0, s44, 16384
    s_add_u32 s45, s59, 0
    buffer_load_dwordx4 v9, s[8:11], s45 offen  lds
    s_add_u32 m0, s44, 4096
    s_add_u32 s45, s58, 32768
    buffer_load_dwordx4 v8, s[12:15], s45 offen sc1 lds
    s_add_u32 m0, s44, 20480
    s_add_u32 s45, s59, 65536
    buffer_load_dwordx4 v9, s[8:11], s45 offen  lds
    s_add_u32 m0, s44, 8192
    s_add_u32 s45, s58, 65536
    buffer_load_dwordx4 v8, s[12:15], s45 offen sc1 lds
    s_add_u32 m0, s44, 24576
    s_add_u32 s45, s59, 131072
    buffer_load_dwordx4 v9, s[8:11], s45 offen  lds
    s_add_u32 m0, s44, 12288
    s_add_u32 s45, s58, 98304
    buffer_load_dwordx4 v8, s[12:15], s45 offen sc1 lds
    s_add_u32 m0, s44, 28672
    s_add_u32 s45, s59, 196608
    buffer_load_dwordx4 v9, s[8:11], s45 offen  lds
    s_add_u32 s47, s47, 1
    s_add_u32 s43, s43, 32768
    s_cmp_eq_u32 s43, 131072
    s_cselect_b32 s43, 0, s43
    s_mov_b32 s60, 0
L_g2_ploop:
    s_waitcnt vmcnt(8)
    s_barrier
    v_readfirstlane_b32 s56, v10
    s_nop 0
    s_cmp_lg_u32 s56, 0
    s_cbranch_scc1 L_g2_fok5
    s_mov_b32 s61, 0
L_g2_fpoll5:
    s_sleep 4
    buffer_load_dword v10, v11, s[36:39], s54 offen sc0 sc1
    s_waitcnt vmcnt(0)
    v_readfirstlane_b32 s56, v10
    s_add_u32 s61, s61, 1
    s_cmp_ge_u32 s61, 0x20000
    s_cbranch_scc1 L_g2_fok5
    s_cmp_eq_u32 s56, 0
    s_cbranch_scc1 L_g2_fpoll5
L_g2_fok5:
    s_add_u32 s61, s47, 1
    s_add_u32 s56, s52, s61
    s_and_b32 s56, s56, 3
    s_cmp_lt_u32 s61, 2
    s_cselect_b32 s56, 1, s56
    s_and_b32 s59, s61, 0xfffffffe
    s_cmp_eq_u32 s59, 24
    s_cselect_b32 s59, 7, 31
    s_cmp_eq_u32 s56, 0
    s_cselect_b32 s56, s59, 27
    s_add_u32 s56, s56, s61
    s_add_u32 s56, s56, s55
    s_cmp_ge_u32 s56, 56
    s_cselect_b32 s59, 56, 28
    s_cmp_ge_u32 s56, 28
    s_cselect_b32 s59, s59, 0
    s_sub_u32 s56, s56, s59
    s_cmp_ge_u32 s56, 28
    s_cselect_b32 s59, 28, 0
    s_sub_u32 s56, s56, s59
    s_add_u32 s56, s56, s63
    s_lshr_b32 s54, s56, 1
    s_lshl_b32 s54, s54, 7
    s_add_u32 s54, s54, s57
    buffer_load_dword v10, v11, s[36:39], s54 offen sc0 sc1
    s_add_u32 s58, s52, s47
    s_and_b32 s58, s58, 3
    s_cmp_lt_u32 s47, 2
    s_cselect_b32 s58, 1, s58
    s_and_b32 s59, s47, 0xfffffffe
    s_cmp_eq_u32 s59, 24
    s_cselect_b32 s59, 7, 31
    s_cmp_eq_u32 s58, 0
    s_cselect_b32 s58, s59, 27
    s_add_u32 s58, s58, s47
    s_add_u32 s58, s58, s55
    s_cmp_ge_u32 s58, 56
    s_cselect_b32 s59, 56, 28
    s_cmp_ge_u32 s58, 28
    s_cselect_b32 s59, s59, 0
    s_sub_u32 s58, s58, s59
    s_cmp_ge_u32 s58, 28
    s_cselect_b32 s59, 28, 0
    s_sub_u32 s58, s58, s59
    s_add_u32 s58, s58, s63
    s_mul_i32 s59, s58, 262144
    s_lshl_b32 s58, s58, 17
    s_add_u32 s58, s58, s40
    s_add_u32 s59, s59, s41
    s_add_u32 s44, s43, s42
    s_add_u32 m0, s44, 0
    s_add_u32 s45, s58, 0
    buffer_load_dwordx4 v8, s[12:15], s45 offen sc1 lds
    s_add_u32 m0, s44, 16384
    s_add_u32 s45, s59, 0
    buffer_load_dwordx4 v9, s[8:11], s45 offen  lds
    s_add_u32 m0, s44, 4096
    s_add_u32 s45, s58, 32768
    buffer_load_dwordx4 v8, s[12:15], s45 offen sc1 lds
    s_add_u32 m0, s44, 20480
    s_add_u32 s45, s59, 65536
    buffer_load_dwordx4 v9, s[8:11], s45 offen  lds
    s_add_u32 m0, s44, 8192
    s_add_u32 s45, s58, 65536
    buffer_load_dwordx4 v8, s[12:15], s45 offen sc1 lds
    s_add_u32 m0, s44, 24576
    s_add_u32 s45, s59, 131072
    buffer_load_dwordx4 v9, s[8:11], s45 offen  lds
    s_add_u32 m0, s44, 12288
    s_add_u32 s45, s58, 98304
    buffer_load_dwordx4 v8, s[12:15], s45 offen sc1 lds
    s_add_u32 m0, s44, 28672
    s_add_u32 s45, s59, 196608
    buffer_load_dwordx4 v9, s[8:11], s45 offen  lds
    s_add_u32 s47, s47, 1
    s_add_u32 s43, s43, 32768
    s_cmp_eq_u32 s43, 131072
    s_cselect_b32 s43, 0, s43
    s_add_u32 s60, s60, 1
    s_cmp_lt_u32 s60, 25
    s_cbranch_scc1 L_g2_ploop
    s_waitcnt vmcnt(8)
    s_barrier
    s_waitcnt vmcnt(0)
    s_barrier
L_gg_end:
    s_endpgm
L_text_end:
.section .rodata,"a"
.p2align 6
.amdhsa_kernel p1_kernel
  .amdhsa_next_free_vgpr 236
  .amdhsa_next_free_sgpr 96
  .amdhsa_accum_offset 236
  .amdhsa_group_segment_fixed_size 0
  .amdhsa_kernarg_size 88
  .amdhsa_user_sgpr_count 2
  .amdhsa_user_sgpr_kernarg_segment_ptr 1
  .amdhsa_system_sgpr_workgroup_id_x 1
.end_amdhsa_kernel
.p2align 6
.amdhsa_kernel mega_kernel
  .amdhsa_next_free_vgpr 256
  .amdhsa_next_free_sgpr 96
  .amdhsa_accum_offset 256
  .amdhsa_group_segment_fixed_size 0
  .amdhsa_kernarg_size 88
  .amdhsa_user_sgpr_count 2
  .amdhsa_user_sgpr_kernarg_segment_ptr 1
  .amdhsa_system_sgpr_workgroup_id_x 1
.end_amdhsa_kernel
```
